```python
import torch

def _softmax(x, axis=-1):
    return torch.softmax(x, dim=axis)
def _gelu(x):
    return torch.nn.functional.gelu(x, approximate="tanh")
def _silu(x):
    return torch.nn.functional.silu(x)
def _sigmoid(x):
    return torch.sigmoid(x)
def _layernorm(x, axis=-1, eps=1e-5):
    m = x.mean(dim=axis, keepdim=True)
    v = x.var(dim=axis, keepdim=True, unbiased=False)
    return (x - m) / torch.sqrt(v + eps)
def _scatter_add(tgt, idx, src, axis=0):
    return tgt.clone().index_add_(axis, idx, src)
def _segment_sum(src, seg, n):
    out = torch.zeros((n,) + src.shape[1:], dtype=src.dtype)
    return out.index_add_(0, seg, src)
def _pad(x, pw):
    flat = tuple(v for pair in reversed(pw) for v in pair)
    return torch.nn.functional.pad(x, flat)

kernel_name = 'standalone__grouped__vision'

def setup_inputs():

    _w = (lambda a: (lambda t: t.to(torch.bfloat16) if t.is_floating_point() else t)(torch.as_tensor(a)))
    H = W = 224
    G = 4
    Cg = max(96 // G, 2)
    C = G * Cg
    k = 7
    scale = 1.0 / (k * Cg ** 0.5)
    return {
        "x": _w((lambda *s: torch.randn(*s, dtype=torch.bfloat16) * 0.05)(1, H, W, C)),
        "w": _w((lambda *s: torch.randn(*s, dtype=torch.bfloat16) * 0.05)(k, k, G, Cg, Cg) * scale),
    }

def reference(x, w):
    B, H, W, C = x.shape
    k = w.shape[0]
    G = w.shape[2]
    Cg = C // G
    pad = k // 2
    xp = _pad(x, ((0,0),(pad,pad),(pad,pad),(0,0)))
    xg = xp.reshape(B, H + 2 * pad, W + 2 * pad, G, Cg)
    out = torch.zeros_like(x).reshape(B, H, W, G, Cg)
    for i in range(k):
        for j in range(k):
            out = out + torch.einsum('bhwgc,gcd->bhwgd', xg[:, i:i+H, j:j+W, :, :], w[i, j])
    return out.reshape(B, H, W, C)
```

```asm
; @launch grid=(256,1,1) block=(256,1,1) lds=143872
.amdgcn_target "amdgcn-amd-amdhsa--gfx950"
.text
.globl standalone__grouped__vision_kernel
.p2align 12
.p2align 8
.type standalone__grouped__vision_kernel,@function
standalone__grouped__vision_kernel:
    s_load_dwordx2 s[12:13], s[0:1], 8
    s_load_dwordx2 s[8:9], s[0:1], 0
    s_load_dwordx2 s[16:17], s[0:1], 16
    s_cmp_ge_u32 s2, 256
    s_cbranch_scc1 L_end
    s_getpc_b64 s[20:21]
L_pc:
    s_mov_b32 s22, L_end - L_pc
    s_mov_b32 s23, 0x20000
    v_lshrrev_b32 v80, 6, v0
    s_lshr_b32 s31, s2, 3
    s_lshl_b32 s31, s31, 9
    v_lshl_add_u32 v24, v80, 7, s31
    v_lshl_or_b32 v24, v0, 26, v24
    buffer_load_dword v24, v24, s[20:23], 0 offen
    v_readfirstlane_b32 s24, v80
    v_and_b32 v1, 63, v0
    s_bfe_u32 s25, s2, 0x20003
    s_mov_b32 s44, 0xd8
    s_mul_i32 s31, s25, 1152
    s_movk_i32 s32, -24
    s_movk_i32 s33, -46
    v_lshlrev_b32 v80, 1, v0
    v_sub_u32 v80, v80, v1
    v_mul_u32_u24 v81, 2731, v80
    v_lshrrev_b32 v81, 16, v81
    v_mad_i32_i24 v82, v81, s32, v80
    v_lshlrev_b32 v85, 1, v81
    v_and_b32 v85, 6, v85
    v_bfe_u32 v85, s44, v85, 2
    v_and_or_b32 v83, v81, 28, v85
    v_mul_u32_u24 v84, 86, v83
    v_lshrrev_b32 v84, 8, v84
    v_mad_u32_u24 v84, v84, 9, v83
    v_cmp_gt_u32 vcc, 16, v82
    v_mul_u32_u24 v84, 384, v84
    v_lshrrev_b32 v85, 1, v82
    v_lshl_add_u32 v86, v82, 1, s33
    v_cndmask_b32 v85, v86, v85, vcc
    v_add_lshl_u32 v85, v85, v82, 4
    v_add3_u32 v14, v84, v85, s31
    v_add_u32 v80, 64, v80
    v_mul_u32_u24 v81, 2731, v80
    v_lshrrev_b32 v81, 16, v81
    v_mad_i32_i24 v82, v81, s32, v80
    v_lshlrev_b32 v85, 1, v81
    v_and_b32 v85, 6, v85
    v_bfe_u32 v85, s44, v85, 2
    v_and_or_b32 v83, v81, 28, v85
    v_mul_u32_u24 v84, 86, v83
    v_lshrrev_b32 v84, 8, v84
    v_mad_u32_u24 v84, v84, 9, v83
    v_cmp_gt_u32 vcc, 16, v82
    v_mul_u32_u24 v84, 384, v84
    v_lshrrev_b32 v85, 1, v82
    v_lshl_add_u32 v86, v82, 1, s33
    v_cndmask_b32 v85, v86, v85, vcc
    v_add_lshl_u32 v85, v85, v82, 4
    v_add3_u32 v15, v84, v85, s31
    s_and_b32 s31, s2, 7
    s_lshr_b32 s32, s2, 5
    s_lshl_b32 s31, s31, 5
    s_lshl_b32 s32, s32, 2
    s_add_u32 s32, s32, s31
    s_add_u32 s32, s32, s24
    s_mul_i32 s33, s32, 4682
    s_lshr_b32 s33, s33, 16
    s_mul_i32 s26, s33, 12
    s_mul_i32 s33, s33, 14
    s_sub_u32 s27, s32, s33
    s_lshl_b32 s27, s27, 4
    s_mul_i32 s28, s24, 19456
    s_add_u32 s28, s28, 66048
    s_lshl_b32 s29, s24, 11
    s_mul_i32 s45, s25, 48
    v_mul_u32_u24 v88, 86, v1
    v_lshrrev_b32 v88, 8, v88
    s_sub_u32 s32, s27, 3
    v_add_u32 v90, s32, v88
    v_mul_u32_u24 v89, 144, v88
    v_cmp_gt_u32 vcc, 224, v90
    v_lshl_add_u32 v89, v1, 4, v89
    s_mul_i32 s32, s32, 192
    s_add_u32 s32, s32, s45
    v_add_u32 v16, s32, v89
    v_mov_b32 v91, 1073741824
    v_cndmask_b32 v16, v91, v16, vcc
    s_mov_b32 s7, 43008
    s_mul_i32 s34, s26, s7
    v_add_u32 v17, s34, v16
    s_mov_b32 s10, 9633792
    s_mov_b32 s11, 0x20000
    s_mov_b32 s14, 225792
    s_mov_b32 s15, 0x20000
    s_mov_b32 s37, 32256
    s_waitcnt lgkmcnt(0)
    s_add_u32 m0, s29, 0
    s_nop 0
    buffer_load_dwordx4 v14, s[12:15], 0 offen lds
    s_add_u32 m0, s29, 1024
    s_nop 0
    buffer_load_dwordx4 v15, s[12:15], 0 offen lds
    s_add_u32 m0, s28, 4096
    v_add_u32 v18, 43008, v17
    buffer_load_dwordx4 v18, s[8:11], 0 offen lds
    s_add_u32 m0, s29, 8256
    s_nop 0
    buffer_load_dwordx4 v14, s[12:15], s37 offen lds
    s_add_u32 m0, s29, 9280
    s_nop 0
    buffer_load_dwordx4 v15, s[12:15], s37 offen lds
    s_add_u32 m0, s28, 5120
    v_add_u32 v18, s7, v18
    buffer_load_dwordx4 v18, s[8:11], 0 offen lds
    s_mov_b32 s18, 9633792
    s_mov_b32 s19, 0x20000
    s_add_u32 s38, s37, s37
    s_add_u32 s39, s38, s37
    s_add_u32 s40, s39, s37
    s_add_u32 s41, s40, s37
    s_add_u32 s42, s41, s37
    s_sub_u32 s30, s34, s7
    v_lshrrev_b32 v29, 1, v1
    s_sub_u32 s31, s26, 3
    v_add_u32 v34, s31, v29
    s_cmp_eq_u32 s27, 208
    s_cselect_b32 s33, 0, 18
    v_cmp_gt_u32 vcc, 224, v34
    v_cmp_gt_u32 s[46:47], s33, v29
    v_mul_u32_u24 v34, s7, v34
    v_and_b32 v30, 1, v1
    s_and_b64 vcc, vcc, s[46:47]
    s_add_u32 s33, s32, 4048
    v_lshl_add_u32 v36, v30, 4, s33
    v_add_u32 v34, v34, v36
    v_cndmask_b32 v19, v91, v34, vcc
    s_and_b64 vcc, vcc, 0xff00
    v_cndmask_b32 v32, v91, v34, vcc
    s_add_u32 m0, s28, 18432
    s_nop 0
    buffer_load_dwordx4 v32, s[8:11], 0 offen lds
    s_mov_b64 exec, 0
    s_cmp_eq_u32 s24, 0
    s_cbranch_scc1 L_hop0
    s_cmp_eq_u32 s24, 1
    s_cbranch_scc1 L_hop1
    s_cmp_eq_u32 s24, 2
    s_cbranch_scc1 L_varA
L_hopback:
    s_mov_b64 exec, -1
    v_mov_b32 v40, 0
    v_mov_b32 v41, 0
    v_mov_b32 v42, 0
    v_mov_b32 v43, 0
    v_lshlrev_b32 v84, 4, v0
    ds_write_b128 v84, v[40:43] offset:57792
    ds_write_b128 v84, v[40:43] offset:61888
    v_and_b32 v80, 15, v1
    v_lshrrev_b32 v81, 4, v1
    s_mov_b32 s46, 0x75316420
    s_mov_b32 s47, 0xeca8fdb9
    v_lshlrev_b32 v84, 2, v80
    s_add_u32 m0, s29, 16512
    s_nop 0
    buffer_load_dwordx4 v14, s[12:15], s38 offen lds
    v_lshrrev_b64 v[82:83], v84, s[46:47]
    v_and_b32 v82, 15, v82
    v_lshlrev_b32 v84, 1, v81
    v_bfe_u32 v84, s44, v84, 2
    v_mad_u32_u24 v84, v82, 3, v84
    v_lshl_add_u32 v2, v84, 4, s28
    v_cmp_eq_u32 vcc, 59, v1
    s_add_u32 s31, s28, 18432
    v_add_u32 v3, 256, v2
    v_mov_b32 v84, s31
    v_mov_b32 v85, 1024
    v_cndmask_b32 v3, v3, v84, vcc
    s_add_u32 m0, s29, 17536
    s_nop 0
    buffer_load_dwordx4 v15, s[12:15], s38 offen lds
    v_cndmask_b32 v4, v85, 32, vcc
    v_mad_u32_u24 v3, v4, 4, v3
    v_mul_u32_u24 v84, 384, v81
    v_lshl_add_u32 v7, v80, 3, v84
    v_lshrrev_b32 v86, 2, v80
    v_lshlrev_b32 v86, 4, v86
    v_and_b32 v87, 1, v80
    v_lshl_add_u32 v86, v87, 3, v86
    v_add_u32 v86, 256, v86
    v_bfe_u32 v83, v80, 1, 1
    v_add_u32 v85, v84, v86
    v_mul_u32_u24 v87, 57792, v83
    s_add_u32 m0, s29, 24768
    s_nop 0
    buffer_load_dwordx4 v14, s[12:15], s39 offen lds
    v_add_u32 v9, v85, v87
    v_mul_u32_u24 v87, 8256, v83
    v_sub_u32 v8, v85, v87
    v_add_u32 v8, 8256, v8
    s_add_u32 m0, s29, 25792
    s_nop 0
    buffer_load_dwordx4 v15, s[12:15], s39 offen lds
    s_waitcnt vmcnt(8) lgkmcnt(0)
    ds_read_b128 v[92:95], v2 offset:4096
    ds_read_b128 v[96:99], v2 offset:4160
    ds_read_b128 v[100:103], v2 offset:4224
    ds_read_b128 v[104:107], v2 offset:4288
    s_barrier
    ds_read_b64_tr_b16 a[0:1], v7 offset:0
    ds_read_b64_tr_b16 a[2:3], v7 offset:128
    ds_read_b64_tr_b16 a[4:5], v7 offset:1536
    ds_read_b64_tr_b16 a[6:7], v7 offset:1664
    ds_read_b64_tr_b16 a[8:9], v7 offset:3072
    ds_read_b64_tr_b16 a[10:11], v7 offset:3200
    ds_read_b64_tr_b16 a[12:13], v7 offset:4608
    ds_read_b64_tr_b16 a[14:15], v7 offset:4736
    ds_read_b64_tr_b16 a[140:141], v9 offset:0
    ds_read_b64_tr_b16 a[142:143], v9 offset:64
    ds_read_b64_tr_b16 a[144:145], v9 offset:1536
    ds_read_b64_tr_b16 a[146:147], v9 offset:1600
    ds_read_b64_tr_b16 a[148:149], v9 offset:3072
    ds_read_b64_tr_b16 a[150:151], v9 offset:3136
    s_add_u32 m0, s28, 6144
    v_add_u32 v18, s7, v18
    buffer_load_dwordx4 v18, s[8:11], 0 offen lds
    s_add_u32 m0, s28, 7168
    v_add_u32 v18, s7, v18
    buffer_load_dwordx4 v18, s[8:11], 0 offen lds
    s_waitcnt lgkmcnt(12)
    v_mfma_f32_16x16x32_bf16 v[56:59], a[0:3], v[92:95], 0
    s_waitcnt lgkmcnt(10)
    ds_read_b64_tr_b16 a[152:153], v9 offset:4608
    ds_read_b64_tr_b16 a[154:155], v9 offset:4672
    v_mfma_f32_16x16x32_bf16 v[56:59], a[4:7], v[96:99], v[56:59]
    s_waitcnt vmcnt(8)
    s_barrier
    s_waitcnt lgkmcnt(10)
    ds_read_b64_tr_b16 a[20:21], v7 offset:8256
    ds_read_b64_tr_b16 a[22:23], v7 offset:8384
    v_mfma_f32_16x16x32_bf16 v[56:59], a[8:11], v[100:103], v[56:59]
    s_waitcnt lgkmcnt(10)
    ds_read_b64_tr_b16 a[24:25], v7 offset:9792
    ds_read_b64_tr_b16 a[26:27], v7 offset:9920
    v_mfma_f32_16x16x32_bf16 v[56:59], a[12:15], v[104:107], v[56:59]
    s_waitcnt lgkmcnt(10)
    ds_read_b64_tr_b16 a[28:29], v7 offset:11328
    ds_read_b64_tr_b16 a[30:31], v7 offset:11456
    v_mfma_f32_16x16x32_bf16 v[64:67], a[140:143], v[92:95], 0
    s_waitcnt lgkmcnt(10)
    ds_read_b64_tr_b16 a[32:33], v7 offset:12864
    ds_read_b64_tr_b16 a[34:35], v7 offset:12992
    v_mfma_f32_16x16x32_bf16 v[64:67], a[144:147], v[96:99], v[64:67]
    s_waitcnt vmcnt(7) lgkmcnt(10)
    ds_read_b128 v[112:115], v2 offset:5120
    v_mul_u32_u24 v84, 8256, v81
    v_mfma_f32_16x16x32_bf16 v[64:67], a[148:151], v[100:103], v[64:67]
    s_waitcnt lgkmcnt(9)
    ds_read_b128 v[116:119], v2 offset:5184
    ds_read_b128 v[120:123], v2 offset:5248
    v_mfma_f32_16x16x32_bf16 v[64:67], a[152:155], v[104:107], v[64:67]
    s_waitcnt lgkmcnt(9)
    ds_read_b128 v[124:127], v2 offset:5312
    v_lshlrev_b32 v85, 3, v80
    v_mfma_f32_16x16x32_bf16 v[48:51], a[20:23], v[92:95], 0
    s_waitcnt lgkmcnt(8)
    ds_read_b64_tr_b16 a[160:161], v8 offset:0
    ds_read_b64_tr_b16 a[162:163], v8 offset:64
    v_mfma_f32_16x16x32_bf16 v[48:51], a[24:27], v[96:99], v[48:51]
    s_waitcnt lgkmcnt(8)
    ds_read_b64_tr_b16 a[164:165], v8 offset:1536
    v_add_u32 v85, 7680, v85
    v_mfma_f32_16x16x32_bf16 v[48:51], a[28:31], v[100:103], v[48:51]
    s_waitcnt lgkmcnt(7)
    ds_read_b64_tr_b16 a[166:167], v8 offset:1600
    ds_read_b64_tr_b16 a[168:169], v8 offset:3072
    v_mfma_f32_16x16x32_bf16 v[48:51], a[32:35], v[104:107], v[48:51]
    s_waitcnt lgkmcnt(8)
    ds_read_b64_tr_b16 a[170:171], v8 offset:3136
    v_add_u32 v10, v84, v85
    v_mfma_f32_16x16x32_bf16 v[60:63], a[0:3], v[112:115], 0
    s_waitcnt lgkmcnt(8)
    ds_read_b64_tr_b16 a[172:173], v8 offset:4608
    ds_read_b64_tr_b16 a[174:175], v8 offset:4672
    v_mfma_f32_16x16x32_bf16 v[60:63], a[4:7], v[116:119], v[60:63]
    s_waitcnt lgkmcnt(9)
    ds_read_b64_tr_b16 a[16:17], v7 offset:6144
    v_subrev_u32 v87, 1, v81
    v_mfma_f32_16x16x32_bf16 v[60:63], a[8:11], v[120:123], v[60:63]
    s_waitcnt vmcnt(6) lgkmcnt(9)
    ds_read_b64_tr_b16 a[18:19], v7 offset:6272
    ds_read_b128 v[108:111], v3
    v_mfma_f32_16x16x32_bf16 v[60:63], a[12:15], v[124:127], v[60:63]
    ds_read_b64_tr_b16 a[156:157], v9 offset:6144
    v_add_u32 v3, v4, v3
    v_mfma_f32_16x16x32_bf16 v[56:59], a[20:23], v[112:115], v[56:59]
    ds_read_b64_tr_b16 a[158:159], v9 offset:6208
    ds_read_b64_tr_b16 a[36:37], v7 offset:14400
    v_mfma_f32_16x16x32_bf16 v[56:59], a[24:27], v[116:119], v[56:59]
    ds_read_b64_tr_b16 a[38:39], v7 offset:14528
    v_and_b32 v87, 7, v87
    v_mfma_f32_16x16x32_bf16 v[56:59], a[28:31], v[120:123], v[56:59]
    ds_read_b128 v[128:131], v3
    ds_read_b64_tr_b16 a[176:177], v8 offset:6144
    v_mfma_f32_16x16x32_bf16 v[56:59], a[32:35], v[124:127], v[56:59]
    s_waitcnt lgkmcnt(12)
    ds_read_b64_tr_b16 a[178:179], v8 offset:6208
    v_add_u32 v3, v4, v3
    v_mfma_f32_16x16x32_bf16 v[64:67], a[160:163], v[112:115], v[64:67]
    s_add_u32 m0, s29, 33024
    v_mul_u32_u24 v87, 8256, v87
    v_add_u32 v11, v87, v85
    v_mfma_f32_16x16x32_bf16 v[64:67], a[164:167], v[116:119], v[64:67]
    s_waitcnt lgkmcnt(10)
    buffer_load_dwordx4 v14, s[12:15], s40 offen lds
    v_mfma_f32_16x16x32_bf16 v[64:67], a[168:171], v[120:123], v[64:67]
    s_add_u32 m0, s29, 34048
    v_add_u32 v86, 7680, v86
    v_sub_u32 v87, v81, v83
    v_mfma_f32_16x16x32_bf16 v[64:67], a[172:175], v[124:127], v[64:67]
    s_waitcnt vmcnt(3)
    s_barrier
    s_waitcnt lgkmcnt(7)
    ds_read_b64_tr_b16 a[40:41], v7 offset:16512
    ds_read_b64_tr_b16 a[42:43], v7 offset:16640
    v_mfma_f32_16x16x32_bf16 v[56:59], a[16:19], v[108:111], v[56:59]
    s_waitcnt lgkmcnt(7)
    ds_read_b64_tr_b16 a[44:45], v7 offset:18048
    ds_read_b64_tr_b16 a[46:47], v7 offset:18176
    v_mfma_f32_16x16x32_bf16 v[64:67], a[156:159], v[108:111], v[64:67]
    s_waitcnt lgkmcnt(7)
    ds_read_b64_tr_b16 a[48:49], v7 offset:19584
    ds_read_b64_tr_b16 a[50:51], v7 offset:19712
    v_mfma_f32_16x16x32_bf16 v[48:51], a[36:39], v[108:111], v[48:51]
    s_waitcnt lgkmcnt(8)
    ds_read_b64_tr_b16 a[52:53], v7 offset:21120
    ds_read_b64_tr_b16 a[54:55], v7 offset:21248
    v_mfma_f32_16x16x32_bf16 v[60:63], a[16:19], v[128:131], v[60:63]
    ds_read_b64_tr_b16 a[56:57], v7 offset:22656
    ds_read_b64_tr_b16 a[58:59], v7 offset:22784
    v_mfma_f32_16x16x32_bf16 v[56:59], a[36:39], v[128:131], v[56:59]
    s_waitcnt lgkmcnt(10)
    buffer_load_dwordx4 v15, s[12:15], s40 offen lds
    ds_read_b64_tr_b16 a[180:181], v8 offset:8256
    v_mfma_f32_16x16x32_bf16 v[64:67], a[176:179], v[128:131], v[64:67]
    s_waitcnt lgkmcnt(9)
    ds_read_b64_tr_b16 a[182:183], v8 offset:8320
    ds_read_b64_tr_b16 a[184:185], v8 offset:9792
    v_mfma_f32_16x16x32_bf16 v[44:47], a[40:43], v[92:95], 0
    s_waitcnt lgkmcnt(9)
    ds_read_b64_tr_b16 a[186:187], v8 offset:9856
    s_add_u32 m0, s29, 41280
    v_mfma_f32_16x16x32_bf16 v[44:47], a[44:47], v[96:99], v[44:47]
    s_waitcnt lgkmcnt(8)
    ds_read_b64_tr_b16 a[188:189], v8 offset:11328
    ds_read_b64_tr_b16 a[190:191], v8 offset:11392
    v_mfma_f32_16x16x32_bf16 v[44:47], a[48:51], v[100:103], v[44:47]
    s_waitcnt lgkmcnt(8)
    buffer_load_dwordx4 v14, s[12:15], s41 offen lds
    ds_read_b64_tr_b16 a[192:193], v8 offset:12864
    v_mfma_f32_16x16x32_bf16 v[44:47], a[52:55], v[104:107], v[44:47]
    s_waitcnt lgkmcnt(7)
    ds_read_b64_tr_b16 a[194:195], v8 offset:12928
    ds_read_b64_tr_b16 a[196:197], v8 offset:14400
    v_mfma_f32_16x16x32_bf16 v[44:47], a[56:59], v[108:111], v[44:47]
    s_add_u32 m0, s29, 42304
    ds_read_b64_tr_b16 a[198:199], v8 offset:14464
    v_add_u32 v85, 1, v87
    v_mfma_f32_16x16x32_bf16 v[48:51], a[40:43], v[112:115], v[48:51]
    ds_read_b64_tr_b16 a[60:61], v7 offset:24768
    ds_read_b64_tr_b16 a[62:63], v7 offset:24896
    v_mfma_f32_16x16x32_bf16 v[48:51], a[44:47], v[116:119], v[48:51]
    buffer_load_dwordx4 v15, s[12:15], s41 offen lds
    ds_read_b64_tr_b16 a[64:65], v7 offset:26304
    v_mfma_f32_16x16x32_bf16 v[48:51], a[48:51], v[120:123], v[48:51]
    ds_read_b64_tr_b16 a[66:67], v7 offset:26432
    ds_read_b64_tr_b16 a[68:69], v7 offset:27840
    v_mfma_f32_16x16x32_bf16 v[48:51], a[52:55], v[124:127], v[48:51]
    ds_read_b64_tr_b16 a[70:71], v7 offset:27968
    v_mul_u32_u24 v85, 8256, v85
    v_mfma_f32_16x16x32_bf16 v[48:51], a[56:59], v[128:131], v[48:51]
    s_waitcnt lgkmcnt(12)
    ds_read_b64_tr_b16 a[72:73], v7 offset:29376
    ds_read_b64_tr_b16 a[74:75], v7 offset:29504
    v_mfma_f32_16x16x32_bf16 v[52:55], a[180:183], v[92:95], 0
    ds_read_b64_tr_b16 a[76:77], v7 offset:30912
    v_add_u32 v12, v85, v86
    v_mfma_f32_16x16x32_bf16 v[52:55], a[184:187], v[96:99], v[52:55]
    s_waitcnt lgkmcnt(12)
    ds_read_b64_tr_b16 a[78:79], v7 offset:31040
    ds_read_b64_tr_b16 a[200:201], v8 offset:16512
    v_mfma_f32_16x16x32_bf16 v[52:55], a[188:191], v[100:103], v[52:55]
    s_waitcnt lgkmcnt(12)
    ds_read_b64_tr_b16 a[202:203], v8 offset:16576
    v_and_b32 v87, 7, v87
    v_mfma_f32_16x16x32_bf16 v[52:55], a[192:195], v[104:107], v[52:55]
    s_waitcnt lgkmcnt(12)
    ds_read_b64_tr_b16 a[204:205], v8 offset:18048
    ds_read_b64_tr_b16 a[206:207], v8 offset:18112
    v_mfma_f32_16x16x32_bf16 v[52:55], a[196:199], v[108:111], v[52:55]
    s_waitcnt lgkmcnt(12)
    ds_read_b64_tr_b16 a[208:209], v8 offset:19584
    v_mul_u32_u24 v87, 8256, v87
    v_mfma_f32_16x16x32_bf16 v[44:47], a[60:63], v[112:115], v[44:47]
    s_waitcnt lgkmcnt(11)
    ds_read_b64_tr_b16 a[210:211], v8 offset:19648
    ds_read_b64_tr_b16 a[212:213], v8 offset:21120
    v_mfma_f32_16x16x32_bf16 v[44:47], a[64:67], v[116:119], v[44:47]
    s_waitcnt lgkmcnt(11)
    ds_read_b64_tr_b16 a[214:215], v8 offset:21184
    v_add_u32 v13, v87, v86
    v_mfma_f32_16x16x32_bf16 v[44:47], a[68:71], v[120:123], v[44:47]
    s_waitcnt lgkmcnt(10)
    ds_read_b64_tr_b16 a[216:217], v8 offset:22656
    ds_read_b64_tr_b16 a[218:219], v8 offset:22720
    v_mfma_f32_16x16x32_bf16 v[44:47], a[72:75], v[124:127], v[44:47]
    s_waitcnt vmcnt(5) lgkmcnt(10)
    ds_read_b128 v[132:135], v2 offset:6144
    v_cmp_eq_u32 vcc, 15, v82
    v_mfma_f32_16x16x32_bf16 v[44:47], a[76:79], v[128:131], v[44:47]
    s_waitcnt lgkmcnt(9)
    ds_read_b128 v[136:139], v2 offset:6208
    s_add_u32 m0, s28, 18432
    v_mfma_f32_16x16x32_bf16 v[52:55], a[200:203], v[112:115], v[52:55]
    s_waitcnt lgkmcnt(8)
    buffer_load_dwordx4 v19, s[8:11], 0 offen lds
    ds_read_b128 v[140:143], v2 offset:6272
    v_mfma_f32_16x16x32_bf16 v[52:55], a[204:207], v[116:119], v[52:55]
    s_waitcnt lgkmcnt(7)
    ds_read_b128 v[144:147], v2 offset:6336
    v_mul_u32_u24 v5, 48, v82
    v_mfma_f32_16x16x32_bf16 v[52:55], a[208:211], v[120:123], v[52:55]
    s_waitcnt lgkmcnt(6)
    ds_read_b128 v[148:151], v3
    v_lshl_add_u32 v5, v81, 10, v5
    v_mfma_f32_16x16x32_bf16 v[52:55], a[212:215], v[124:127], v[52:55]
    s_waitcnt vmcnt(5) lgkmcnt(5)
    ds_read_b128 v[152:155], v2 offset:7168
    v_add_u32 v3, v4, v3
    v_mfma_f32_16x16x32_bf16 v[52:55], a[216:219], v[128:131], v[52:55]
    s_waitcnt lgkmcnt(5)
    ds_read_b128 v[156:159], v2 offset:7232
    s_add_u32 s32, s28, 320
    v_mfma_f32_16x16x32_bf16 v[68:71], a[0:3], v[132:135], 0
    s_waitcnt lgkmcnt(5)
    ds_read_b128 v[160:163], v2 offset:7296
    v_add_u32 v5, s32, v5
    v_mfma_f32_16x16x32_bf16 v[68:71], a[4:7], v[136:139], v[68:71]
    s_waitcnt lgkmcnt(5)
    ds_read_b128 v[164:167], v2 offset:7360
    s_add_u32 s31, s31, 16
    v_mfma_f32_16x16x32_bf16 v[68:71], a[8:11], v[140:143], v[68:71]
    s_waitcnt lgkmcnt(5)
    ds_read_b128 v[168:171], v3
    v_lshl_add_u32 v84, v81, 5, s31
    v_mfma_f32_16x16x32_bf16 v[68:71], a[12:15], v[144:147], v[68:71]
    s_waitcnt lgkmcnt(5)
    ds_read_b64_tr_b16 v[224:225], v10 offset:0
    v_mad_i32_i24 v3, v4, -5, v3
    v_mfma_f32_16x16x32_bf16 v[68:71], a[16:19], v[148:151], v[68:71]
    s_waitcnt lgkmcnt(5)
    ds_read_b64_tr_b16 v[226:227], v10 offset:128
    v_mov_b32 v85, 2048
    v_mfma_f32_16x16x32_bf16 v[68:71], a[20:23], v[152:155], v[68:71]
    s_waitcnt lgkmcnt(5)
    ds_read_b64_tr_b16 v[232:233], v11 offset:0
    v_cndmask_b32 v5, v5, v84, vcc
    v_mfma_f32_16x16x32_bf16 v[68:71], a[24:27], v[156:159], v[68:71]
    s_waitcnt lgkmcnt(5)
    ds_read_b64_tr_b16 v[234:235], v11 offset:128
    v_cndmask_b32 v6, v85, 64, vcc
    v_mfma_f32_16x16x32_bf16 v[68:71], a[28:31], v[160:163], v[68:71]
    s_waitcnt lgkmcnt(5)
    ds_read_b64_tr_b16 v[240:241], v13 offset:0
    v_mad_u32_u24 v5, v6, 2, v5
    v_mfma_f32_16x16x32_bf16 v[68:71], a[32:35], v[164:167], v[68:71]
    s_waitcnt lgkmcnt(5)
    ds_read_b64_tr_b16 v[242:243], v13 offset:64
    v_mul_u32_u24 v84, 48, v82
    v_mfma_f32_16x16x32_bf16 v[68:71], a[36:39], v[168:171], v[68:71]
    v_add_u32 v84, s28, v84
    v_lshl_add_u32 v20, v81, 3, v84
    v_mfma_f32_16x16x32_bf16 v[72:75], a[0:3], v[152:155], 0
    v_lshrrev_b32 v83, 1, v81
    v_mul_u32_u24 v85, 768, v83
    v_mfma_f32_16x16x32_bf16 v[72:75], a[4:7], v[156:159], v[72:75]
    v_and_b32 v86, 1, v81
    v_lshl_add_u32 v85, v86, 3, v85
    v_mfma_f32_16x16x32_bf16 v[72:75], a[8:11], v[160:163], v[72:75]
    v_add3_u32 v21, v84, v85, 32
    v_lshl_add_u32 v22, v1, 4, s28
    v_mfma_f32_16x16x32_bf16 v[72:75], a[12:15], v[164:167], v[72:75]
    s_mul_i32 s32, s27, 192
    s_add_u32 s32, s32, s45
    v_cmp_gt_u32 vcc, 48, v1
    v_mfma_f32_16x16x32_bf16 v[72:75], a[16:19], v[168:171], v[72:75]
    s_add_u32 m0, s29, 49536
    v_add_u32 v23, s32, v89
    s_nop 0
    v_mfma_f32_16x16x32_bf16 v[76:79], a[140:143], v[132:135], 0
    buffer_load_dwordx4 v14, s[12:15], s42 offen lds
    v_mfma_f32_16x16x32_bf16 v[76:79], a[144:147], v[136:139], v[76:79]
    s_add_u32 m0, s29, 50560
    v_cndmask_b32 v23, v91, v23, vcc
    s_and_b32 s31, s2, 7
    v_mfma_f32_16x16x32_bf16 v[76:79], a[148:151], v[140:143], v[76:79]
    buffer_load_dwordx4 v15, s[12:15], s42 offen lds
    v_mfma_f32_16x16x32_bf16 v[76:79], a[152:155], v[144:147], v[76:79]
    s_sub_u32 s6, s34, 43008
    s_cselect_b32 s6, 1073741824, s6
    s_add_u32 m0, s28, 2048
    v_mfma_f32_16x16x32_bf16 v[76:79], a[156:159], v[148:151], v[76:79]
    v_add_u32 v18, s6, v16
    s_lshr_b32 s32, s2, 5
    v_mfma_f32_16x16x32_bf16 v[76:79], a[160:163], v[152:155], v[76:79]
    buffer_load_dwordx4 v18, s[8:11], 0 offen lds
    v_mfma_f32_16x16x32_bf16 v[76:79], a[164:167], v[156:159], v[76:79]
    s_mul_i32 s4, s31, 5
    s_add_u32 s4, s4, s32
    v_mfma_f32_16x16x32_bf16 v[76:79], a[168:171], v[160:163], v[76:79]
    s_cmp_lt_u32 s32, 5
    s_cselect_b32 s35, s24, 3
    s_lshr_b32 s5, s4, 2
    v_mfma_f32_16x16x32_bf16 v[76:79], a[172:175], v[164:167], v[76:79]
    s_lshl_b32 s5, s5, 4
    s_add_u32 s5, s5, 64
    s_and_b32 s4, s4, 3
    v_mfma_f32_16x16x32_bf16 v[76:79], a[176:179], v[168:171], v[76:79]
    s_lshl_b32 s4, s4, 1
    s_add_u32 s31, s4, 213
    s_mul_i32 s31, s31, s7
    v_mfma_f32_16x16x32_bf16 v[56:59], a[40:43], v[132:135], v[56:59]
    s_mul_i32 s33, s5, 192
    s_add_u32 s31, s31, s33
    s_sub_u32 s31, s31, 640
    v_mfma_f32_16x16x32_bf16 v[56:59], a[44:47], v[136:139], v[56:59]
    s_cmp_lt_u32 s32, 5
    s_cselect_b32 s31, s31, 1073741824
    s_lshl_b32 s33, s25, 2
    v_mfma_f32_16x16x32_bf16 v[56:59], a[48:51], v[140:143], v[56:59]
    s_add_u32 s33, s33, s24
    s_mul_i32 s33, s33, 20
    v_add_u32 v84, s33, v1
    v_mfma_f32_16x16x32_bf16 v[56:59], a[52:55], v[144:147], v[56:59]
    v_cmp_gt_u32 vcc, 20, v1
    v_mul_u32_u24 v85, 1928, v84
    v_mfma_f32_16x16x32_bf16 v[56:59], a[56:59], v[148:151], v[56:59]
    s_add_u32 m0, s28, 3072
    v_add_u32 v18, 0, v17
    v_lshrrev_b32 v85, 16, v85
    v_mfma_f32_16x16x32_bf16 v[56:59], a[60:63], v[152:155], v[56:59]
    buffer_load_dwordx4 v18, s[8:11], 0 offen lds
    v_mfma_f32_16x16x32_bf16 v[56:59], a[64:67], v[156:159], v[56:59]
    v_mul_u32_u24 v85, 38656, v85
    v_lshl_add_u32 v84, v84, 7, v85
    v_mfma_f32_16x16x32_bf16 v[56:59], a[68:71], v[160:163], v[56:59]
    v_add_u32 v84, s31, v84
    v_cndmask_b32 v28, v91, v84, vcc
    v_mfma_f32_16x16x32_bf16 v[56:59], a[72:75], v[164:167], v[56:59]
    s_and_b32 s31, s35, 1
    s_add_u32 s4, s4, s31
    s_add_u32 s4, s4, 216
    v_mfma_f32_16x16x32_bf16 v[56:59], a[76:79], v[168:171], v[56:59]
    s_mul_i32 s31, s4, s7
    s_mul_i32 s32, s5, 192
    s_add_u32 s31, s31, s32
    v_mfma_f32_16x16x32_bf16 v[60:63], a[20:23], v[132:135], v[60:63]
    s_add_u32 s31, s31, s45
    s_cmp_eq_u32 s35, 3
    s_cselect_b32 s31, 1073741824, s31
    v_mfma_f32_16x16x32_bf16 v[60:63], a[24:27], v[136:139], v[60:63]
    s_sub_u32 s32, s31, 129600
    s_sub_u32 s33, s5, 3
    v_add_u32 v90, s33, v88
    v_mfma_f32_16x16x32_bf16 v[60:63], a[28:31], v[140:143], v[60:63]
    v_cmp_gt_u32 vcc, 224, v90
    v_add_u32 v25, s32, v89
    v_mfma_f32_16x16x32_bf16 v[60:63], a[32:35], v[144:147], v[60:63]
    v_mul_u32_u24 v84, s7, v29
    v_cndmask_b32 v25, v91, v25, vcc
    v_mfma_f32_16x16x32_bf16 v[60:63], a[36:39], v[148:151], v[60:63]
    s_add_u32 s32, s32, -81968
    s_cmp_eq_u32 s5, 208
    s_cselect_b32 s32, 1073741824, s32
    v_mfma_f32_16x16x32_bf16 v[60:63], a[40:43], v[152:155], v[60:63]
    v_lshl_add_u32 v84, v30, 4, v84
    v_add_u32 v26, s32, v84
    v_mfma_f32_16x16x32_bf16 v[60:63], a[44:47], v[156:159], v[60:63]
    v_mul_u32_u24 v84, 192, v82
    v_add_u32 v84, s31, v84
    v_mfma_f32_16x16x32_bf16 v[60:63], a[48:51], v[160:163], v[60:63]
    s_cmp_eq_u32 s35, 2
    s_cselect_b32 s32, 42992, 0
    s_cselect_b32 s33, 32, 0
    v_mfma_f32_16x16x32_bf16 v[60:63], a[52:55], v[164:167], v[60:63]
    v_mul_u32_u24 v85, s32, v83
    v_lshl_add_u32 v84, v81, 3, v84
    v_mfma_f32_16x16x32_bf16 v[60:63], a[56:59], v[168:171], v[60:63]
    s_waitcnt vmcnt(5)
    s_barrier
    ds_read_b64_tr_b16 a[80:81], v7 offset:33024
    ds_read_b64_tr_b16 a[82:83], v7 offset:33152
    v_mfma_f32_16x16x32_bf16 v[64:67], a[180:183], v[132:135], v[64:67]
    ds_read_b64_tr_b16 a[84:85], v7 offset:34560
    v_add3_u32 v27, v84, v85, s33
    v_mfma_f32_16x16x32_bf16 v[64:67], a[184:187], v[136:139], v[64:67]
    ds_read_b64_tr_b16 a[86:87], v7 offset:34688
    ds_read_b64_tr_b16 a[88:89], v7 offset:36096
    v_mfma_f32_16x16x32_bf16 v[64:67], a[188:191], v[140:143], v[64:67]
    ds_read_b64_tr_b16 a[90:91], v7 offset:36224
    v_mfma_f32_16x16x32_bf16 v[64:67], a[192:195], v[144:147], v[64:67]
    ds_read_b64_tr_b16 a[92:93], v7 offset:37632
    ds_read_b64_tr_b16 a[94:95], v7 offset:37760
    v_mfma_f32_16x16x32_bf16 v[64:67], a[196:199], v[148:151], v[64:67]
    ds_read_b64_tr_b16 a[96:97], v7 offset:39168
    v_mfma_f32_16x16x32_bf16 v[64:67], a[200:203], v[152:155], v[64:67]
    ds_read_b64_tr_b16 a[98:99], v7 offset:39296
    ds_read_b64_tr_b16 a[220:221], v8 offset:24768
    v_mfma_f32_16x16x32_bf16 v[64:67], a[204:207], v[156:159], v[64:67]
    ds_read_b64_tr_b16 a[222:223], v8 offset:24832
    v_mfma_f32_16x16x32_bf16 v[64:67], a[208:211], v[160:163], v[64:67]
    ds_read_b64_tr_b16 a[224:225], v8 offset:26304
    ds_read_b64_tr_b16 a[226:227], v8 offset:26368
    v_mfma_f32_16x16x32_bf16 v[64:67], a[212:215], v[164:167], v[64:67]
    ds_read_b64_tr_b16 a[228:229], v8 offset:27840
    v_mfma_f32_16x16x32_bf16 v[64:67], a[216:219], v[168:171], v[64:67]
    ds_read_b64_tr_b16 a[230:231], v8 offset:27904
    ds_read_b64_tr_b16 a[232:233], v8 offset:29376
    v_mfma_f32_16x16x32_bf16 v[36:39], a[60:63], v[92:95], 0
    ds_read_b64_tr_b16 a[234:235], v8 offset:29440
    v_mfma_f32_16x16x32_bf16 v[36:39], a[64:67], v[96:99], v[36:39]
    ds_read_b64_tr_b16 a[236:237], v8 offset:30912
    v_mfma_f32_16x16x32_bf16 v[36:39], a[68:71], v[100:103], v[36:39]
    ds_read_b64_tr_b16 a[238:239], v8 offset:30976
L_hop0:
    s_cbranch_execz L_hop0_1
    v_mfma_f32_16x16x32_bf16 v[36:39], a[72:75], v[104:107], v[36:39]
    ds_read_b64_tr_b16 a[100:101], v7 offset:41280
    v_mfma_f32_16x16x32_bf16 v[36:39], a[76:79], v[108:111], v[36:39]
    s_waitcnt lgkmcnt(10)
    ds_read_b64_tr_b16 a[102:103], v7 offset:41408
    v_mfma_f32_16x16x32_bf16 v[32:35], a[80:83], v[92:95], 0
    ds_read_b64_tr_b16 a[104:105], v7 offset:42816
    v_mfma_f32_16x16x32_bf16 v[32:35], a[84:87], v[96:99], v[32:35]
    ds_read_b64_tr_b16 a[106:107], v7 offset:42944
    v_mfma_f32_16x16x32_bf16 v[32:35], a[88:91], v[100:103], v[32:35]
    ds_read_b64_tr_b16 a[108:109], v7 offset:44352
    v_mfma_f32_16x16x32_bf16 v[32:35], a[92:95], v[104:107], v[32:35]
    ds_read_b64_tr_b16 a[110:111], v7 offset:44480
    v_mfma_f32_16x16x32_bf16 v[32:35], a[96:99], v[108:111], v[32:35]
    ds_read_b64_tr_b16 a[112:113], v7 offset:45888
    v_mfma_f32_16x16x32_bf16 v[36:39], a[80:83], v[112:115], v[36:39]
    ds_read_b64_tr_b16 a[114:115], v7 offset:46016
    v_mfma_f32_16x16x32_bf16 v[36:39], a[84:87], v[116:119], v[36:39]
    ds_read_b64_tr_b16 a[116:117], v7 offset:47424
    v_mfma_f32_16x16x32_bf16 v[36:39], a[88:91], v[120:123], v[36:39]
    ds_read_b64_tr_b16 a[118:119], v7 offset:47552
    v_mfma_f32_16x16x32_bf16 v[36:39], a[92:95], v[124:127], v[36:39]
    ds_read_b64_tr_b16 a[240:241], v8 offset:33024
    v_mfma_f32_16x16x32_bf16 v[36:39], a[96:99], v[128:131], v[36:39]
    s_waitcnt lgkmcnt(8)
    ds_read_b64_tr_b16 a[242:243], v8 offset:33088
L_hop0_1:
    s_cbranch_execz L_hop0_2
    v_mfma_f32_16x16x32_bf16 v[40:43], a[220:223], v[92:95], 0
    ds_read_b64_tr_b16 a[244:245], v8 offset:34560
    v_mfma_f32_16x16x32_bf16 v[40:43], a[224:227], v[96:99], v[40:43]
    ds_read_b64_tr_b16 a[246:247], v8 offset:34624
    v_mfma_f32_16x16x32_bf16 v[40:43], a[228:231], v[100:103], v[40:43]
    ds_read_b64_tr_b16 a[248:249], v8 offset:36096
    v_mfma_f32_16x16x32_bf16 v[40:43], a[232:235], v[104:107], v[40:43]
    s_sub_u32 s6, s34, 129024
    ds_read_b64_tr_b16 a[250:251], v8 offset:36160
    s_cselect_b32 s6, 1073741824, s6
    v_mfma_f32_16x16x32_bf16 v[40:43], a[236:239], v[108:111], v[40:43]
    s_add_u32 m0, s28, 0
    ds_read_b64_tr_b16 a[252:253], v8 offset:37632
    v_add_u32 v18, s6, v16
    v_mfma_f32_16x16x32_bf16 v[32:35], a[100:103], v[112:115], v[32:35]
    s_waitcnt lgkmcnt(8)
    ds_read_b64_tr_b16 a[254:255], v8 offset:37696
    v_mfma_f32_16x16x32_bf16 v[32:35], a[104:107], v[116:119], v[32:35]
    ds_read_b64_tr_b16 v[180:181], v8 offset:39168
    v_mfma_f32_16x16x32_bf16 v[32:35], a[108:111], v[120:123], v[32:35]
    ds_read_b64_tr_b16 v[182:183], v8 offset:39232
    v_mfma_f32_16x16x32_bf16 v[32:35], a[112:115], v[124:127], v[32:35]
    s_waitcnt lgkmcnt(8)
    buffer_load_dwordx4 v18, s[8:11], 0 offen lds
    v_mfma_f32_16x16x32_bf16 v[32:35], a[116:119], v[128:131], v[32:35]
    v_mfma_f32_16x16x32_bf16 v[40:43], a[240:243], v[112:115], v[40:43]
    s_waitcnt lgkmcnt(6)
    v_mfma_f32_16x16x32_bf16 v[40:43], a[244:247], v[116:119], v[40:43]
    s_waitcnt lgkmcnt(4)
L_hop0_2:
    s_cbranch_execz L_hopback
    v_mfma_f32_16x16x32_bf16 v[40:43], a[248:251], v[120:123], v[40:43]
    s_waitcnt lgkmcnt(2)
    v_mfma_f32_16x16x32_bf16 v[40:43], a[252:255], v[124:127], v[40:43]
    s_waitcnt lgkmcnt(0)
    v_mfma_f32_16x16x32_bf16 v[40:43], v[180:183], v[128:131], v[40:43]
    v_mfma_f32_16x16x32_bf16 v[44:47], a[80:83], v[132:135], v[44:47]
    v_mfma_f32_16x16x32_bf16 v[44:47], a[84:87], v[136:139], v[44:47]
    v_mfma_f32_16x16x32_bf16 v[44:47], a[88:91], v[140:143], v[44:47]
    s_sub_u32 s6, s34, 86016
    s_cselect_b32 s6, 1073741824, s6
    s_add_u32 m0, s28, 1024
    v_mfma_f32_16x16x32_bf16 v[44:47], a[92:95], v[144:147], v[44:47]
    v_add_u32 v18, s6, v16
    v_mfma_f32_16x16x32_bf16 v[44:47], a[96:99], v[148:151], v[44:47]
    buffer_load_dwordx4 v18, s[8:11], 0 offen lds
    v_mfma_f32_16x16x32_bf16 v[44:47], a[100:103], v[152:155], v[44:47]
    v_mfma_f32_16x16x32_bf16 v[44:47], a[104:107], v[156:159], v[44:47]
    v_mfma_f32_16x16x32_bf16 v[44:47], a[108:111], v[160:163], v[44:47]
    v_mfma_f32_16x16x32_bf16 v[44:47], a[112:115], v[164:167], v[44:47]
    v_mfma_f32_16x16x32_bf16 v[44:47], a[116:119], v[168:171], v[44:47]
    v_mfma_f32_16x16x32_bf16 v[48:51], a[60:63], v[132:135], v[48:51]
    v_mfma_f32_16x16x32_bf16 v[48:51], a[64:67], v[136:139], v[48:51]
    v_mfma_f32_16x16x32_bf16 v[48:51], a[68:71], v[140:143], v[48:51]
    v_mfma_f32_16x16x32_bf16 v[48:51], a[72:75], v[144:147], v[48:51]
    v_mfma_f32_16x16x32_bf16 v[48:51], a[76:79], v[148:151], v[48:51]
    v_mfma_f32_16x16x32_bf16 v[48:51], a[80:83], v[152:155], v[48:51]
    v_mfma_f32_16x16x32_bf16 v[48:51], a[84:87], v[156:159], v[48:51]
    s_add_u32 m0, s28, 8192
    v_add_u32 v18, 215040, v17
    v_mfma_f32_16x16x32_bf16 v[48:51], a[88:91], v[160:163], v[48:51]
    buffer_load_dwordx4 v18, s[8:11], 0 offen lds
    v_mfma_f32_16x16x32_bf16 v[48:51], a[92:95], v[164:167], v[48:51]
    v_mfma_f32_16x16x32_bf16 v[48:51], a[96:99], v[168:171], v[48:51]
    s_waitcnt vmcnt(5)
    s_barrier
    ds_read_b64_tr_b16 a[120:121], v7 offset:49536
    ds_read_b64_tr_b16 a[122:123], v7 offset:49664
    v_mfma_f32_16x16x32_bf16 v[52:55], a[220:223], v[132:135], v[52:55]
    ds_read_b64_tr_b16 a[124:125], v7 offset:51072
    v_mfma_f32_16x16x32_bf16 v[52:55], a[224:227], v[136:139], v[52:55]
    ds_read_b64_tr_b16 a[126:127], v7 offset:51200
    ds_read_b64_tr_b16 a[128:129], v7 offset:52608
    v_mfma_f32_16x16x32_bf16 v[52:55], a[228:231], v[140:143], v[52:55]
    ds_read_b64_tr_b16 a[130:131], v7 offset:52736
    v_mfma_f32_16x16x32_bf16 v[52:55], a[232:235], v[144:147], v[52:55]
    ds_read_b64_tr_b16 a[132:133], v7 offset:54144
    v_mfma_f32_16x16x32_bf16 v[52:55], a[236:239], v[148:151], v[52:55]
    ds_read_b64_tr_b16 a[134:135], v7 offset:54272
    v_mfma_f32_16x16x32_bf16 v[52:55], a[240:243], v[152:155], v[52:55]
    ds_read_b64_tr_b16 a[136:137], v7 offset:55680
    v_mfma_f32_16x16x32_bf16 v[52:55], a[244:247], v[156:159], v[52:55]
    ds_read_b64_tr_b16 a[138:139], v7 offset:55808
    v_mfma_f32_16x16x32_bf16 v[52:55], a[248:251], v[160:163], v[52:55]
    ds_read_b64_tr_b16 v[184:185], v8 offset:41280
    v_mfma_f32_16x16x32_bf16 v[52:55], a[252:255], v[164:167], v[52:55]
    ds_read_b64_tr_b16 v[186:187], v8 offset:41344
    v_mfma_f32_16x16x32_bf16 v[52:55], v[180:183], v[168:171], v[52:55]
    ds_read_b64_tr_b16 v[188:189], v8 offset:42816
    v_mfma_f32_16x16x32_bf16 v[36:39], a[100:103], v[132:135], v[36:39]
    s_add_u32 m0, s28, 9216
    ds_read_b64_tr_b16 v[190:191], v8 offset:42880
    v_add_u32 v18, s7, v18
    v_mfma_f32_16x16x32_bf16 v[36:39], a[104:107], v[136:139], v[36:39]
    ds_read_b64_tr_b16 v[192:193], v8 offset:44352
    v_mfma_f32_16x16x32_bf16 v[36:39], a[108:111], v[140:143], v[36:39]
    ds_read_b64_tr_b16 v[194:195], v8 offset:44416
    v_mfma_f32_16x16x32_bf16 v[36:39], a[112:115], v[144:147], v[36:39]
    ds_read_b64_tr_b16 v[196:197], v8 offset:45888
    v_mfma_f32_16x16x32_bf16 v[36:39], a[116:119], v[148:151], v[36:39]
    s_waitcnt lgkmcnt(8)
    ds_read_b64_tr_b16 v[198:199], v8 offset:45952
    v_mfma_f32_16x16x32_bf16 v[32:35], a[120:123], v[132:135], v[32:35]
    ds_read_b64_tr_b16 v[200:201], v8 offset:47424
    v_mfma_f32_16x16x32_bf16 v[32:35], a[124:127], v[136:139], v[32:35]
    ds_read_b64_tr_b16 v[202:203], v8 offset:47488
    v_mfma_f32_16x16x32_bf16 v[32:35], a[128:131], v[140:143], v[32:35]
    ds_read_b64_tr_b16 v[204:205], v8 offset:49536
    v_mfma_f32_16x16x32_bf16 v[32:35], a[132:135], v[144:147], v[32:35]
    s_waitcnt lgkmcnt(8)
    ds_read_b64_tr_b16 v[206:207], v8 offset:49600
    v_mfma_f32_16x16x32_bf16 v[32:35], a[136:139], v[148:151], v[32:35]
    ds_read_b64_tr_b16 v[208:209], v8 offset:51072
    v_mfma_f32_16x16x32_bf16 v[36:39], a[120:123], v[152:155], v[36:39]
    ds_read_b64_tr_b16 v[210:211], v8 offset:51136
    v_mfma_f32_16x16x32_bf16 v[36:39], a[124:127], v[156:159], v[36:39]
    ds_read_b64_tr_b16 v[212:213], v8 offset:52608
    v_mfma_f32_16x16x32_bf16 v[36:39], a[128:131], v[160:163], v[36:39]
    ds_read_b64_tr_b16 v[214:215], v8 offset:52672
    v_mfma_f32_16x16x32_bf16 v[36:39], a[132:135], v[164:167], v[36:39]
    ds_read_b64_tr_b16 v[216:217], v8 offset:54144
    v_mfma_f32_16x16x32_bf16 v[36:39], a[136:139], v[168:171], v[36:39]
    ds_read_b64_tr_b16 v[218:219], v8 offset:54208
    v_mfma_f32_16x16x32_bf16 v[40:43], v[184:187], v[132:135], v[40:43]
    s_waitcnt lgkmcnt(8)
    ds_read_b64_tr_b16 v[220:221], v8 offset:55680
    v_mfma_f32_16x16x32_bf16 v[40:43], v[188:191], v[136:139], v[40:43]
    ds_read_b64_tr_b16 v[222:223], v8 offset:55744
    v_mfma_f32_16x16x32_bf16 v[40:43], v[192:195], v[140:143], v[40:43]
    ds_read_b128 v[172:175], v5
    v_mfma_f32_16x16x32_bf16 v[40:43], v[196:199], v[144:147], v[40:43]
    ds_read_b64_tr_b16 v[228:229], v10 offset:33024
    v_mad_i32_i24 v5, v6, -1, v5
    v_mfma_f32_16x16x32_bf16 v[40:43], v[200:203], v[148:151], v[40:43]
    s_waitcnt lgkmcnt(8)
    ds_read_b64_tr_b16 v[230:231], v10 offset:33152
    v_mfma_f32_16x16x32_bf16 v[40:43], v[204:207], v[152:155], v[40:43]
    ds_read_b64_tr_b16 v[236:237], v10 offset:24768
    v_mfma_f32_16x16x32_bf16 v[40:43], v[208:211], v[156:159], v[40:43]
    s_waitcnt lgkmcnt(8)
    ds_read_b64_tr_b16 v[238:239], v10 offset:24896
    v_mfma_f32_16x16x32_bf16 v[40:43], v[212:215], v[160:163], v[40:43]
    s_waitcnt lgkmcnt(7)
    ds_read_b64_tr_b16 v[244:245], v12 offset:24768
    v_mfma_f32_16x16x32_bf16 v[40:43], v[216:219], v[164:167], v[40:43]
    s_waitcnt lgkmcnt(6)
    ds_read_b64_tr_b16 v[246:247], v12 offset:24832
    v_mfma_f32_16x16x32_bf16 v[40:43], v[220:223], v[168:171], v[40:43]
    s_waitcnt vmcnt(4) lgkmcnt(6)
    ds_read_b128 v[92:95], v2 offset:2048
    v_mfma_f32_16x16x32_bf16 v[56:59], v[224:227], v[172:175], v[56:59]
    ds_read_b128 v[96:99], v2 offset:2112
    v_mfma_f32_16x16x32_bf16 v[60:63], v[232:235], v[172:175], v[60:63]
    ds_read_b128 v[100:103], v2 offset:2176
    v_mfma_f32_16x16x32_bf16 v[64:67], v[240:243], v[172:175], v[64:67]
    s_waitcnt lgkmcnt(7)
    ds_read_b128 v[104:107], v2 offset:2240
    v_mfma_f32_16x16x32_bf16 v[32:35], v[228:231], v[172:175], v[32:35]
    s_waitcnt lgkmcnt(6)
    ds_read_b128 v[108:111], v3
    v_mfma_f32_16x16x32_bf16 v[36:39], v[236:239], v[172:175], v[36:39]
    s_waitcnt vmcnt(3) lgkmcnt(5)
    ds_read_b128 v[112:115], v2 offset:3072
    v_add_u32 v3, v4, v3
    v_mfma_f32_16x16x32_bf16 v[40:43], v[244:247], v[172:175], v[40:43]
    s_waitcnt lgkmcnt(5)
    ds_read_b128 v[116:119], v2 offset:3136
    v_mfma_f32_16x16x32_bf16 v[44:47], a[0:3], v[92:95], v[44:47]
    s_waitcnt lgkmcnt(5)
    ds_read_b128 v[120:123], v2 offset:3200
    v_mfma_f32_16x16x32_bf16 v[44:47], a[4:7], v[96:99], v[44:47]
    s_waitcnt lgkmcnt(5)
    ds_read_b128 v[124:127], v2 offset:3264
    v_mfma_f32_16x16x32_bf16 v[44:47], a[8:11], v[100:103], v[44:47]
    s_waitcnt lgkmcnt(5)
    ds_read_b128 v[128:131], v3
    v_mfma_f32_16x16x32_bf16 v[44:47], a[12:15], v[104:107], v[44:47]
    s_waitcnt lgkmcnt(5)
    v_mad_i32_i24 v3, v4, -3, v3
    v_mfma_f32_16x16x32_bf16 v[44:47], a[16:19], v[108:111], v[44:47]
    s_waitcnt lgkmcnt(4)
    buffer_load_dwordx4 v18, s[8:11], 0 offen lds
    v_mfma_f32_16x16x32_bf16 v[44:47], a[20:23], v[112:115], v[44:47]
    s_waitcnt lgkmcnt(3)
    buffer_load_dword v24, v28, s[8:11], 0 offen
    v_mfma_f32_16x16x32_bf16 v[44:47], a[24:27], v[116:119], v[44:47]
    s_waitcnt lgkmcnt(2)
    v_mfma_f32_16x16x32_bf16 v[44:47], a[28:31], v[120:123], v[44:47]
    s_waitcnt lgkmcnt(1)
    v_mfma_f32_16x16x32_bf16 v[44:47], a[32:35], v[124:127], v[44:47]
    s_waitcnt lgkmcnt(0)
    v_mfma_f32_16x16x32_bf16 v[44:47], a[36:39], v[128:131], v[44:47]
    v_mfma_f32_16x16x32_bf16 v[48:51], a[0:3], v[112:115], v[48:51]
    v_mfma_f32_16x16x32_bf16 v[48:51], a[4:7], v[116:119], v[48:51]
    v_mfma_f32_16x16x32_bf16 v[48:51], a[8:11], v[120:123], v[48:51]
    v_mfma_f32_16x16x32_bf16 v[48:51], a[12:15], v[124:127], v[48:51]
    v_mfma_f32_16x16x32_bf16 v[48:51], a[16:19], v[128:131], v[48:51]
    v_mfma_f32_16x16x32_bf16 v[52:55], a[140:143], v[92:95], v[52:55]
    v_mfma_f32_16x16x32_bf16 v[52:55], a[144:147], v[96:99], v[52:55]
    v_mfma_f32_16x16x32_bf16 v[52:55], a[148:151], v[100:103], v[52:55]
    v_mfma_f32_16x16x32_bf16 v[52:55], a[152:155], v[104:107], v[52:55]
    v_mfma_f32_16x16x32_bf16 v[52:55], a[156:159], v[108:111], v[52:55]
    v_mfma_f32_16x16x32_bf16 v[52:55], a[160:163], v[112:115], v[52:55]
    v_mfma_f32_16x16x32_bf16 v[52:55], a[164:167], v[116:119], v[52:55]
    v_mfma_f32_16x16x32_bf16 v[52:55], a[168:171], v[120:123], v[52:55]
    v_mfma_f32_16x16x32_bf16 v[52:55], a[172:175], v[124:127], v[52:55]
    v_mfma_f32_16x16x32_bf16 v[52:55], a[176:179], v[128:131], v[52:55]
    v_mfma_f32_16x16x32_bf16 v[32:35], a[40:43], v[92:95], v[32:35]
    v_mfma_f32_16x16x32_bf16 v[32:35], a[44:47], v[96:99], v[32:35]
    v_mfma_f32_16x16x32_bf16 v[32:35], a[48:51], v[100:103], v[32:35]
    v_mfma_f32_16x16x32_bf16 v[32:35], a[52:55], v[104:107], v[32:35]
    v_mfma_f32_16x16x32_bf16 v[32:35], a[56:59], v[108:111], v[32:35]
    v_mfma_f32_16x16x32_bf16 v[32:35], a[60:63], v[112:115], v[32:35]
    ds_read_b128 v[176:179], v5
    v_mfma_f32_16x16x32_bf16 v[32:35], a[64:67], v[116:119], v[32:35]
    v_mad_i32_i24 v5, v6, -1, v5
    v_mfma_f32_16x16x32_bf16 v[32:35], a[68:71], v[120:123], v[32:35]
    v_mfma_f32_16x16x32_bf16 v[32:35], a[72:75], v[124:127], v[32:35]
    s_waitcnt vmcnt(4)
    ds_read_b128 v[132:135], v2 offset:0
    v_mfma_f32_16x16x32_bf16 v[32:35], a[76:79], v[128:131], v[32:35]
    ds_read_b128 v[136:139], v2 offset:64
    v_mfma_f32_16x16x32_bf16 v[36:39], a[20:23], v[92:95], v[36:39]
    ds_read_b128 v[140:143], v2 offset:128
    v_mfma_f32_16x16x32_bf16 v[36:39], a[24:27], v[96:99], v[36:39]
    ds_read_b128 v[144:147], v2 offset:192
    v_mfma_f32_16x16x32_bf16 v[36:39], a[28:31], v[100:103], v[36:39]
    ds_read_b128 v[148:151], v3
    v_mfma_f32_16x16x32_bf16 v[36:39], a[32:35], v[104:107], v[36:39]
    s_waitcnt vmcnt(3)
    ds_read_b128 v[152:155], v2 offset:1024
    v_add_u32 v3, v4, v3
    v_mfma_f32_16x16x32_bf16 v[36:39], a[36:39], v[108:111], v[36:39]
    ds_read_b128 v[156:159], v2 offset:1088
    v_mfma_f32_16x16x32_bf16 v[36:39], a[40:43], v[112:115], v[36:39]
    ds_read_b128 v[160:163], v2 offset:1152
    v_mfma_f32_16x16x32_bf16 v[36:39], a[44:47], v[116:119], v[36:39]
    ds_read_b128 v[164:167], v2 offset:1216
    v_mfma_f32_16x16x32_bf16 v[36:39], a[48:51], v[120:123], v[36:39]
    ds_read_b128 v[168:171], v3
    v_mfma_f32_16x16x32_bf16 v[36:39], a[52:55], v[124:127], v[36:39]
    v_mad_i32_i24 v3, v4, 7, v3
    v_mfma_f32_16x16x32_bf16 v[36:39], a[56:59], v[128:131], v[36:39]
    v_mfma_f32_16x16x32_bf16 v[40:43], a[180:183], v[92:95], v[40:43]
    v_mfma_f32_16x16x32_bf16 v[40:43], a[184:187], v[96:99], v[40:43]
    v_mfma_f32_16x16x32_bf16 v[40:43], a[188:191], v[100:103], v[40:43]
    v_mfma_f32_16x16x32_bf16 v[40:43], a[192:195], v[104:107], v[40:43]
    v_mfma_f32_16x16x32_bf16 v[40:43], a[196:199], v[108:111], v[40:43]
    v_mfma_f32_16x16x32_bf16 v[40:43], a[200:203], v[112:115], v[40:43]
    v_mfma_f32_16x16x32_bf16 v[40:43], a[204:207], v[116:119], v[40:43]
    v_mfma_f32_16x16x32_bf16 v[40:43], a[208:211], v[120:123], v[40:43]
    v_mfma_f32_16x16x32_bf16 v[40:43], a[212:215], v[124:127], v[40:43]
    v_mfma_f32_16x16x32_bf16 v[40:43], a[216:219], v[128:131], v[40:43]
    s_waitcnt lgkmcnt(0)
    v_mfma_f32_16x16x32_bf16 v[44:47], v[224:227], v[176:179], v[44:47]
    v_mfma_f32_16x16x32_bf16 v[48:51], v[232:235], v[176:179], v[48:51]
    v_mfma_f32_16x16x32_bf16 v[52:55], v[240:243], v[176:179], v[52:55]
    v_mfma_f32_16x16x32_bf16 v[32:35], a[0:3], v[132:135], v[32:35]
    ds_read_b128 v[172:175], v5
    v_mfma_f32_16x16x32_bf16 v[32:35], a[4:7], v[136:139], v[32:35]
    v_mad_i32_i24 v5, v6, 3, v5
    v_mfma_f32_16x16x32_bf16 v[32:35], a[8:11], v[140:143], v[32:35]
    v_mfma_f32_16x16x32_bf16 v[32:35], a[12:15], v[144:147], v[32:35]
    s_waitcnt vmcnt(2)
    ds_read_b128 v[92:95], v2 offset:8192
    v_mfma_f32_16x16x32_bf16 v[32:35], a[16:19], v[148:151], v[32:35]
    ds_read_b128 v[96:99], v2 offset:8256
    v_mfma_f32_16x16x32_bf16 v[32:35], a[20:23], v[152:155], v[32:35]
    ds_read_b128 v[100:103], v2 offset:8320
    v_mfma_f32_16x16x32_bf16 v[32:35], a[24:27], v[156:159], v[32:35]
    ds_read_b128 v[104:107], v2 offset:8384
    v_mfma_f32_16x16x32_bf16 v[32:35], a[28:31], v[160:163], v[32:35]
    ds_read_b128 v[108:111], v3
    v_mfma_f32_16x16x32_bf16 v[32:35], a[32:35], v[164:167], v[32:35]
    v_add_u32 v3, v4, v3
    v_mfma_f32_16x16x32_bf16 v[32:35], a[36:39], v[168:171], v[32:35]
    v_mfma_f32_16x16x32_bf16 v[36:39], a[0:3], v[152:155], v[36:39]
    v_mfma_f32_16x16x32_bf16 v[36:39], a[4:7], v[156:159], v[36:39]
    v_mfma_f32_16x16x32_bf16 v[36:39], a[8:11], v[160:163], v[36:39]
    v_mfma_f32_16x16x32_bf16 v[36:39], a[12:15], v[164:167], v[36:39]
    s_waitcnt vmcnt(1)
    ds_read_b128 v[112:115], v2 offset:9216
    s_add_u32 m0, s28, 10240
    v_mfma_f32_16x16x32_bf16 v[36:39], a[16:19], v[168:171], v[36:39]
    ds_read_b128 v[116:119], v2 offset:9280
    v_add_u32 v18, s7, v18
    v_mfma_f32_16x16x32_bf16 v[40:43], a[140:143], v[132:135], v[40:43]
    ds_read_b128 v[120:123], v2 offset:9344
    v_mfma_f32_16x16x32_bf16 v[40:43], a[144:147], v[136:139], v[40:43]
    ds_read_b128 v[124:127], v2 offset:9408
    v_mfma_f32_16x16x32_bf16 v[40:43], a[148:151], v[140:143], v[40:43]
    ds_read_b128 v[128:131], v3
    v_mfma_f32_16x16x32_bf16 v[40:43], a[152:155], v[144:147], v[40:43]
    v_add_u32 v3, v4, v3
    v_mfma_f32_16x16x32_bf16 v[40:43], a[156:159], v[148:151], v[40:43]
    buffer_load_dwordx4 v18, s[8:11], 0 offen lds
    v_mfma_f32_16x16x32_bf16 v[40:43], a[160:163], v[152:155], v[40:43]
    v_mfma_f32_16x16x32_bf16 v[40:43], a[164:167], v[156:159], v[40:43]
    v_mfma_f32_16x16x32_bf16 v[40:43], a[168:171], v[160:163], v[40:43]
    v_mfma_f32_16x16x32_bf16 v[40:43], a[172:175], v[164:167], v[40:43]
    v_mfma_f32_16x16x32_bf16 v[40:43], a[176:179], v[168:171], v[40:43]
    s_waitcnt lgkmcnt(2)
    v_mfma_f32_16x16x32_bf16 v[32:35], v[224:227], v[172:175], v[32:35]
    v_mfma_f32_16x16x32_bf16 v[36:39], v[232:235], v[172:175], v[36:39]
    v_mfma_f32_16x16x32_bf16 v[40:43], v[240:243], v[172:175], v[40:43]
    s_add_u32 m0, s28, 11264
    v_add_u32 v18, s7, v18
    v_mfma_f32_16x16x32_bf16 v[44:47], a[120:123], v[92:95], v[44:47]
    ds_read_b128 v[176:179], v5
    v_mfma_f32_16x16x32_bf16 v[44:47], a[124:127], v[96:99], v[44:47]
    v_add_u32 v5, v6, v5
    v_mfma_f32_16x16x32_bf16 v[44:47], a[128:131], v[100:103], v[44:47]
    buffer_load_dwordx4 v18, s[8:11], 0 offen lds
    v_mfma_f32_16x16x32_bf16 v[44:47], a[132:135], v[104:107], v[44:47]
    v_mfma_f32_16x16x32_bf16 v[44:47], a[136:139], v[108:111], v[44:47]
    v_mfma_f32_16x16x32_bf16 v[48:51], a[100:103], v[92:95], v[48:51]
    v_mfma_f32_16x16x32_bf16 v[48:51], a[104:107], v[96:99], v[48:51]
    v_mfma_f32_16x16x32_bf16 v[48:51], a[108:111], v[100:103], v[48:51]
    v_cvt_pk_bf16_f32 v32, v32, v33
    v_cvt_pk_bf16_f32 v33, v34, v35
    v_mfma_f32_16x16x32_bf16 v[48:51], a[112:115], v[104:107], v[48:51]
    v_cvt_pk_bf16_f32 v36, v36, v37
    v_cvt_pk_bf16_f32 v37, v38, v39
    v_mfma_f32_16x16x32_bf16 v[48:51], a[116:119], v[108:111], v[48:51]
    v_cvt_pk_bf16_f32 v40, v40, v41
    v_cvt_pk_bf16_f32 v41, v42, v43
    v_mfma_f32_16x16x32_bf16 v[48:51], a[120:123], v[112:115], v[48:51]
    ds_write_b64 v20, v[32:33] offset:0
    v_mfma_f32_16x16x32_bf16 v[48:51], a[124:127], v[116:119], v[48:51]
    v_mfma_f32_16x16x32_bf16 v[48:51], a[128:131], v[120:123], v[48:51]
    s_waitcnt lgkmcnt(1)
    s_add_u32 m0, s28, 2048
    v_mfma_f32_16x16x32_bf16 v[48:51], a[132:135], v[124:127], v[48:51]
    buffer_load_dwordx4 v25, s[8:11], 0 offen lds
    v_mfma_f32_16x16x32_bf16 v[48:51], a[136:139], v[128:131], v[48:51]
    ds_write_b64 v20, v[36:37] offset:768
    v_mfma_f32_16x16x32_bf16 v[52:55], v[184:187], v[92:95], v[52:55]
    v_mfma_f32_16x16x32_bf16 v[52:55], v[188:191], v[96:99], v[52:55]
    ds_write_b64 v21, v[40:41] offset:0
    v_mfma_f32_16x16x32_bf16 v[52:55], v[192:195], v[100:103], v[52:55]
    ds_read_b128 v[32:35], v22 offset:0
    v_mfma_f32_16x16x32_bf16 v[52:55], v[196:199], v[104:107], v[52:55]
    ds_read_b128 v[36:39], v22 offset:768
    s_add_u32 s30, s30, s7
    v_mfma_f32_16x16x32_bf16 v[52:55], v[200:203], v[108:111], v[52:55]
    v_mfma_f32_16x16x32_bf16 v[52:55], v[204:207], v[112:115], v[52:55]
    v_mfma_f32_16x16x32_bf16 v[52:55], v[208:211], v[116:119], v[52:55]
    v_mfma_f32_16x16x32_bf16 v[52:55], v[212:215], v[120:123], v[52:55]
    v_mfma_f32_16x16x32_bf16 v[52:55], v[216:219], v[124:127], v[52:55]
    v_mfma_f32_16x16x32_bf16 v[52:55], v[220:223], v[128:131], v[52:55]
    v_mfma_f32_16x16x32_bf16 v[44:47], v[228:231], v[176:179], v[44:47]
    v_mfma_f32_16x16x32_bf16 v[48:51], v[236:239], v[176:179], v[48:51]
    v_mfma_f32_16x16x32_bf16 v[52:55], v[244:247], v[176:179], v[52:55]
    s_waitcnt lgkmcnt(0)
    buffer_store_dwordx4 v[32:35], v23, s[16:19], s30 offen nt
    v_mfma_f32_16x16x32_bf16 v[68:71], v[224:227], v[176:179], v[68:71]
    s_add_u32 s30, s30, s7
    v_mfma_f32_16x16x32_bf16 v[72:75], v[232:235], v[176:179], v[72:75]
    v_mfma_f32_16x16x32_bf16 v[76:79], v[240:243], v[176:179], v[76:79]
    v_mfma_f32_16x16x32_bf16 v[56:59], a[80:83], v[92:95], v[56:59]
    v_mfma_f32_16x16x32_bf16 v[56:59], a[84:87], v[96:99], v[56:59]
    v_mfma_f32_16x16x32_bf16 v[56:59], a[88:91], v[100:103], v[56:59]
    v_mfma_f32_16x16x32_bf16 v[56:59], a[92:95], v[104:107], v[56:59]
    v_mfma_f32_16x16x32_bf16 v[56:59], a[96:99], v[108:111], v[56:59]
    v_mfma_f32_16x16x32_bf16 v[56:59], a[100:103], v[112:115], v[56:59]
    v_mfma_f32_16x16x32_bf16 v[56:59], a[104:107], v[116:119], v[56:59]
    v_mfma_f32_16x16x32_bf16 v[56:59], a[108:111], v[120:123], v[56:59]
    v_mfma_f32_16x16x32_bf16 v[56:59], a[112:115], v[124:127], v[56:59]
    buffer_store_dwordx4 v[36:39], v23, s[16:19], s30 offen nt
    v_mfma_f32_16x16x32_bf16 v[56:59], a[116:119], v[128:131], v[56:59]
    v_cvt_pk_bf16_f32 v44, v44, v45
    v_cvt_pk_bf16_f32 v45, v46, v47
    v_mfma_f32_16x16x32_bf16 v[60:63], a[60:63], v[92:95], v[60:63]
    v_cvt_pk_bf16_f32 v48, v48, v49
    v_cvt_pk_bf16_f32 v49, v50, v51
    v_mfma_f32_16x16x32_bf16 v[60:63], a[64:67], v[96:99], v[60:63]
    s_add_u32 m0, s28, 3072
    v_add_u32 v25, s7, v25
    v_cvt_pk_bf16_f32 v52, v52, v53
    v_mfma_f32_16x16x32_bf16 v[60:63], a[68:71], v[100:103], v[60:63]
    buffer_load_dwordx4 v25, s[8:11], 0 offen lds
    v_mfma_f32_16x16x32_bf16 v[60:63], a[72:75], v[104:107], v[60:63]
    v_cvt_pk_bf16_f32 v53, v54, v55
    v_mfma_f32_16x16x32_bf16 v[60:63], a[76:79], v[108:111], v[60:63]
    ds_write_b64 v20, v[44:45] offset:0
    v_mfma_f32_16x16x32_bf16 v[60:63], a[80:83], v[112:115], v[60:63]
    v_mfma_f32_16x16x32_bf16 v[60:63], a[84:87], v[116:119], v[60:63]
    ds_write_b64 v20, v[48:49] offset:768
    v_mfma_f32_16x16x32_bf16 v[60:63], a[88:91], v[120:123], v[60:63]
    v_mfma_f32_16x16x32_bf16 v[60:63], a[92:95], v[124:127], v[60:63]
    ds_write_b64 v21, v[52:53] offset:0
    v_mfma_f32_16x16x32_bf16 v[60:63], a[96:99], v[128:131], v[60:63]
    ds_read_b128 v[44:47], v22 offset:0
    v_mfma_f32_16x16x32_bf16 v[64:67], a[220:223], v[92:95], v[64:67]
    ds_read_b128 v[48:51], v22 offset:768
    s_add_u32 s30, s30, s7
    v_mfma_f32_16x16x32_bf16 v[64:67], a[224:227], v[96:99], v[64:67]
    v_mfma_f32_16x16x32_bf16 v[64:67], a[228:231], v[100:103], v[64:67]
    v_mfma_f32_16x16x32_bf16 v[64:67], a[232:235], v[104:107], v[64:67]
    v_mfma_f32_16x16x32_bf16 v[64:67], a[236:239], v[108:111], v[64:67]
    v_mfma_f32_16x16x32_bf16 v[64:67], a[240:243], v[112:115], v[64:67]
    v_mfma_f32_16x16x32_bf16 v[64:67], a[244:247], v[116:119], v[64:67]
    v_mfma_f32_16x16x32_bf16 v[64:67], a[248:251], v[120:123], v[64:67]
    v_mfma_f32_16x16x32_bf16 v[64:67], a[252:255], v[124:127], v[64:67]
    v_mfma_f32_16x16x32_bf16 v[64:67], v[180:183], v[128:131], v[64:67]
    s_waitcnt lgkmcnt(0)
    buffer_store_dwordx4 v[44:47], v23, s[16:19], s30 offen nt
    v_mfma_f32_16x16x32_bf16 v[68:71], a[40:43], v[92:95], v[68:71]
    s_add_u32 s30, s30, s7
    v_mfma_f32_16x16x32_bf16 v[68:71], a[44:47], v[96:99], v[68:71]
    v_mfma_f32_16x16x32_bf16 v[68:71], a[48:51], v[100:103], v[68:71]
    v_mfma_f32_16x16x32_bf16 v[68:71], a[52:55], v[104:107], v[68:71]
    v_mfma_f32_16x16x32_bf16 v[68:71], a[56:59], v[108:111], v[68:71]
    v_mfma_f32_16x16x32_bf16 v[68:71], a[60:63], v[112:115], v[68:71]
    v_mfma_f32_16x16x32_bf16 v[68:71], a[64:67], v[116:119], v[68:71]
    v_mfma_f32_16x16x32_bf16 v[68:71], a[68:71], v[120:123], v[68:71]
    v_mfma_f32_16x16x32_bf16 v[68:71], a[72:75], v[124:127], v[68:71]
    v_mfma_f32_16x16x32_bf16 v[68:71], a[76:79], v[128:131], v[68:71]
    v_mfma_f32_16x16x32_bf16 v[72:75], a[20:23], v[92:95], v[72:75]
    v_mfma_f32_16x16x32_bf16 v[72:75], a[24:27], v[96:99], v[72:75]
    s_add_u32 m0, s28, 4096
    v_add_u32 v25, s7, v25
    v_mfma_f32_16x16x32_bf16 v[72:75], a[28:31], v[100:103], v[72:75]
    buffer_load_dwordx4 v25, s[8:11], 0 offen lds
    v_mfma_f32_16x16x32_bf16 v[72:75], a[32:35], v[104:107], v[72:75]
    buffer_store_dwordx4 v[48:51], v23, s[16:19], s30 offen nt
    v_mfma_f32_16x16x32_bf16 v[72:75], a[36:39], v[108:111], v[72:75]
    v_mfma_f32_16x16x32_bf16 v[72:75], a[40:43], v[112:115], v[72:75]
    s_add_u32 m0, s28, 12288
    v_add_u32 v18, s7, v18
    v_mfma_f32_16x16x32_bf16 v[72:75], a[44:47], v[116:119], v[72:75]
    buffer_load_dwordx4 v18, s[8:11], 0 offen lds
    v_mfma_f32_16x16x32_bf16 v[72:75], a[48:51], v[120:123], v[72:75]
    v_mfma_f32_16x16x32_bf16 v[72:75], a[52:55], v[124:127], v[72:75]
    v_mfma_f32_16x16x32_bf16 v[72:75], a[56:59], v[128:131], v[72:75]
    v_mfma_f32_16x16x32_bf16 v[76:79], a[180:183], v[92:95], v[76:79]
    v_mfma_f32_16x16x32_bf16 v[76:79], a[184:187], v[96:99], v[76:79]
    v_mfma_f32_16x16x32_bf16 v[76:79], a[188:191], v[100:103], v[76:79]
    v_mfma_f32_16x16x32_bf16 v[76:79], a[192:195], v[104:107], v[76:79]
    v_mfma_f32_16x16x32_bf16 v[76:79], a[196:199], v[108:111], v[76:79]
    v_mfma_f32_16x16x32_bf16 v[76:79], a[200:203], v[112:115], v[76:79]
    v_mfma_f32_16x16x32_bf16 v[76:79], a[204:207], v[116:119], v[76:79]
    v_mfma_f32_16x16x32_bf16 v[76:79], a[208:211], v[120:123], v[76:79]
    v_mfma_f32_16x16x32_bf16 v[76:79], a[212:215], v[124:127], v[76:79]
    v_mfma_f32_16x16x32_bf16 v[76:79], a[216:219], v[128:131], v[76:79]
    s_add_u32 m0, s28, 13312
    v_add_u32 v18, s7, v18
    v_mfma_f32_16x16x32_bf16 v[80:83], a[0:3], v[92:95], 0
    s_waitcnt vmcnt(9)
    ds_read_b128 v[132:135], v2 offset:10240
    v_mfma_f32_16x16x32_bf16 v[80:83], a[4:7], v[96:99], v[80:83]
    ds_read_b128 v[136:139], v2 offset:10304
    v_mfma_f32_16x16x32_bf16 v[80:83], a[8:11], v[100:103], v[80:83]
    ds_read_b128 v[140:143], v2 offset:10368
    v_mfma_f32_16x16x32_bf16 v[80:83], a[12:15], v[104:107], v[80:83]
    ds_read_b128 v[144:147], v2 offset:10432
    v_mfma_f32_16x16x32_bf16 v[80:83], a[16:19], v[108:111], v[80:83]
    ds_read_b128 v[148:151], v3
    v_mfma_f32_16x16x32_bf16 v[80:83], a[20:23], v[112:115], v[80:83]
    v_add_u32 v3, v4, v3
    v_mfma_f32_16x16x32_bf16 v[80:83], a[24:27], v[116:119], v[80:83]
    buffer_load_dwordx4 v18, s[8:11], 0 offen lds
    v_mfma_f32_16x16x32_bf16 v[80:83], a[28:31], v[120:123], v[80:83]
    v_mfma_f32_16x16x32_bf16 v[80:83], a[32:35], v[124:127], v[80:83]
    v_mfma_f32_16x16x32_bf16 v[80:83], a[36:39], v[128:131], v[80:83]
    v_mfma_f32_16x16x32_bf16 v[84:87], a[0:3], v[112:115], 0
    s_waitcnt vmcnt(9)
    ds_read_b128 v[152:155], v2 offset:11264
    v_mfma_f32_16x16x32_bf16 v[84:87], a[4:7], v[116:119], v[84:87]
    s_add_u32 m0, s28, 5120
    ds_read_b128 v[156:159], v2 offset:11328
    v_add_u32 v25, s7, v25
    v_mfma_f32_16x16x32_bf16 v[84:87], a[8:11], v[120:123], v[84:87]
    ds_read_b128 v[160:163], v2 offset:11392
    v_mfma_f32_16x16x32_bf16 v[84:87], a[12:15], v[124:127], v[84:87]
    ds_read_b128 v[164:167], v2 offset:11456
    v_mfma_f32_16x16x32_bf16 v[84:87], a[16:19], v[128:131], v[84:87]
    ds_read_b128 v[168:171], v3
    v_mfma_f32_16x16x32_bf16 v[88:91], a[140:143], v[92:95], 0
    v_add_u32 v3, v4, v3
    v_mfma_f32_16x16x32_bf16 v[88:91], a[144:147], v[96:99], v[88:91]
    buffer_load_dwordx4 v25, s[8:11], 0 offen lds
    v_mfma_f32_16x16x32_bf16 v[88:91], a[148:151], v[100:103], v[88:91]
    v_mfma_f32_16x16x32_bf16 v[88:91], a[152:155], v[104:107], v[88:91]
    v_mfma_f32_16x16x32_bf16 v[88:91], a[156:159], v[108:111], v[88:91]
    v_mfma_f32_16x16x32_bf16 v[88:91], a[160:163], v[112:115], v[88:91]
    v_mfma_f32_16x16x32_bf16 v[88:91], a[164:167], v[116:119], v[88:91]
    v_mfma_f32_16x16x32_bf16 v[88:91], a[168:171], v[120:123], v[88:91]
    v_mfma_f32_16x16x32_bf16 v[88:91], a[172:175], v[124:127], v[88:91]
    v_mfma_f32_16x16x32_bf16 v[88:91], a[176:179], v[128:131], v[88:91]
    s_waitcnt lgkmcnt(0)
    v_mfma_f32_16x16x32_bf16 v[56:59], a[120:123], v[132:135], v[56:59]
    ds_read_b128 v[172:175], v5
    v_mfma_f32_16x16x32_bf16 v[56:59], a[124:127], v[136:139], v[56:59]
    v_add_u32 v5, v6, v5
    v_mfma_f32_16x16x32_bf16 v[56:59], a[128:131], v[140:143], v[56:59]
    v_mfma_f32_16x16x32_bf16 v[56:59], a[132:135], v[144:147], v[56:59]
    v_mfma_f32_16x16x32_bf16 v[56:59], a[136:139], v[148:151], v[56:59]
    v_mfma_f32_16x16x32_bf16 v[60:63], a[100:103], v[132:135], v[60:63]
    v_mfma_f32_16x16x32_bf16 v[60:63], a[104:107], v[136:139], v[60:63]
    v_mfma_f32_16x16x32_bf16 v[60:63], a[108:111], v[140:143], v[60:63]
    v_mfma_f32_16x16x32_bf16 v[60:63], a[112:115], v[144:147], v[60:63]
    v_mfma_f32_16x16x32_bf16 v[60:63], a[116:119], v[148:151], v[60:63]
    v_mfma_f32_16x16x32_bf16 v[60:63], a[120:123], v[152:155], v[60:63]
    v_mfma_f32_16x16x32_bf16 v[60:63], a[124:127], v[156:159], v[60:63]
    v_mfma_f32_16x16x32_bf16 v[60:63], a[128:131], v[160:163], v[60:63]
    v_mfma_f32_16x16x32_bf16 v[60:63], a[132:135], v[164:167], v[60:63]
    v_mfma_f32_16x16x32_bf16 v[60:63], a[136:139], v[168:171], v[60:63]
    v_mfma_f32_16x16x32_bf16 v[64:67], v[184:187], v[132:135], v[64:67]
    v_mfma_f32_16x16x32_bf16 v[64:67], v[188:191], v[136:139], v[64:67]
    s_add_u32 m0, s28, 6144
    v_add_u32 v25, s7, v25
    v_mfma_f32_16x16x32_bf16 v[64:67], v[192:195], v[140:143], v[64:67]
    buffer_load_dwordx4 v25, s[8:11], 0 offen lds
    v_mfma_f32_16x16x32_bf16 v[64:67], v[196:199], v[144:147], v[64:67]
    v_mfma_f32_16x16x32_bf16 v[64:67], v[200:203], v[148:151], v[64:67]
    v_mfma_f32_16x16x32_bf16 v[64:67], v[204:207], v[152:155], v[64:67]
    v_mfma_f32_16x16x32_bf16 v[64:67], v[208:211], v[156:159], v[64:67]
    v_mfma_f32_16x16x32_bf16 v[64:67], v[212:215], v[160:163], v[64:67]
    v_mfma_f32_16x16x32_bf16 v[64:67], v[216:219], v[164:167], v[64:67]
    v_mfma_f32_16x16x32_bf16 v[64:67], v[220:223], v[168:171], v[64:67]
    s_waitcnt lgkmcnt(0)
L_hop1:
    s_cbranch_execz L_hop1_1
    v_mfma_f32_16x16x32_bf16 v[56:59], v[228:231], v[172:175], v[56:59]
    v_mfma_f32_16x16x32_bf16 v[60:63], v[236:239], v[172:175], v[60:63]
    v_mfma_f32_16x16x32_bf16 v[64:67], v[244:247], v[172:175], v[64:67]
    v_mfma_f32_16x16x32_bf16 v[80:83], v[224:227], v[172:175], v[80:83]
    v_mfma_f32_16x16x32_bf16 v[84:87], v[232:235], v[172:175], v[84:87]
    v_mfma_f32_16x16x32_bf16 v[88:91], v[240:243], v[172:175], v[88:91]
    v_mfma_f32_16x16x32_bf16 v[68:71], a[80:83], v[132:135], v[68:71]
    v_mfma_f32_16x16x32_bf16 v[68:71], a[84:87], v[136:139], v[68:71]
    v_mfma_f32_16x16x32_bf16 v[68:71], a[88:91], v[140:143], v[68:71]
    v_mfma_f32_16x16x32_bf16 v[68:71], a[92:95], v[144:147], v[68:71]
    v_mfma_f32_16x16x32_bf16 v[68:71], a[96:99], v[148:151], v[68:71]
    v_cvt_pk_bf16_f32 v56, v56, v57
    v_cvt_pk_bf16_f32 v57, v58, v59
    v_mfma_f32_16x16x32_bf16 v[68:71], a[100:103], v[152:155], v[68:71]
    s_add_u32 m0, s28, 18432
    v_cvt_pk_bf16_f32 v60, v60, v61
    v_cvt_pk_bf16_f32 v61, v62, v63
L_hop1_1:
    s_cbranch_execz L_hop1_2
    v_mfma_f32_16x16x32_bf16 v[68:71], a[104:107], v[156:159], v[68:71]
    s_mov_b64 exec, 0xffff0
    buffer_load_dwordx4 v26, s[8:11], 0 offen lds
    s_mov_b64 exec, -1
    v_mfma_f32_16x16x32_bf16 v[68:71], a[108:111], v[160:163], v[68:71]
    v_cvt_pk_bf16_f32 v64, v64, v65
    v_cvt_pk_bf16_f32 v65, v66, v67
    v_mfma_f32_16x16x32_bf16 v[68:71], a[112:115], v[164:167], v[68:71]
    ds_write_b64 v20, v[56:57] offset:0
    v_mfma_f32_16x16x32_bf16 v[68:71], a[116:119], v[168:171], v[68:71]
    v_mfma_f32_16x16x32_bf16 v[72:75], a[60:63], v[132:135], v[72:75]
    ds_write_b64 v20, v[60:61] offset:768
    v_mfma_f32_16x16x32_bf16 v[72:75], a[64:67], v[136:139], v[72:75]
    v_mfma_f32_16x16x32_bf16 v[72:75], a[68:71], v[140:143], v[72:75]
    ds_write_b64 v21, v[64:65] offset:0
    v_mfma_f32_16x16x32_bf16 v[72:75], a[72:75], v[144:147], v[72:75]
    ds_read_b128 v[56:59], v22 offset:0
    v_mfma_f32_16x16x32_bf16 v[72:75], a[76:79], v[148:151], v[72:75]
    ds_read_b128 v[60:63], v22 offset:768
    s_add_u32 s30, s30, s7
    v_mfma_f32_16x16x32_bf16 v[72:75], a[80:83], v[152:155], v[72:75]
    s_add_u32 m0, s28, 14336
    v_add_u32 v18, s7, v18
    v_mfma_f32_16x16x32_bf16 v[72:75], a[84:87], v[156:159], v[72:75]
    buffer_load_dwordx4 v18, s[8:11], 0 offen lds
    v_mfma_f32_16x16x32_bf16 v[72:75], a[88:91], v[160:163], v[72:75]
    s_add_u32 m0, s28, 7168
    v_add_u32 v25, s7, v25
L_hop1_2:
    s_cbranch_execz L_hopback
    v_mfma_f32_16x16x32_bf16 v[72:75], a[92:95], v[164:167], v[72:75]
    buffer_load_dwordx4 v25, s[8:11], 0 offen lds
    v_mfma_f32_16x16x32_bf16 v[72:75], a[96:99], v[168:171], v[72:75]
    v_mfma_f32_16x16x32_bf16 v[76:79], a[220:223], v[132:135], v[76:79]
    v_mfma_f32_16x16x32_bf16 v[76:79], a[224:227], v[136:139], v[76:79]
    v_mfma_f32_16x16x32_bf16 v[76:79], a[228:231], v[140:143], v[76:79]
    v_mfma_f32_16x16x32_bf16 v[76:79], a[232:235], v[144:147], v[76:79]
    s_waitcnt lgkmcnt(0)
    buffer_store_dwordx4 v[56:59], v23, s[16:19], s30 offen nt
    v_mfma_f32_16x16x32_bf16 v[76:79], a[236:239], v[148:151], v[76:79]
    s_add_u32 s30, s30, s7
    v_mfma_f32_16x16x32_bf16 v[76:79], a[240:243], v[152:155], v[76:79]
    v_mfma_f32_16x16x32_bf16 v[76:79], a[244:247], v[156:159], v[76:79]
    v_mfma_f32_16x16x32_bf16 v[76:79], a[248:251], v[160:163], v[76:79]
    v_mfma_f32_16x16x32_bf16 v[76:79], a[252:255], v[164:167], v[76:79]
    v_mfma_f32_16x16x32_bf16 v[76:79], v[180:183], v[168:171], v[76:79]
    s_add_u32 m0, s28, 15360
    v_add_u32 v18, s7, v18
    v_mfma_f32_16x16x32_bf16 v[80:83], a[40:43], v[132:135], v[80:83]
    buffer_load_dwordx4 v18, s[8:11], 0 offen lds
    v_mfma_f32_16x16x32_bf16 v[80:83], a[44:47], v[136:139], v[80:83]
    v_mfma_f32_16x16x32_bf16 v[80:83], a[48:51], v[140:143], v[80:83]
    v_mfma_f32_16x16x32_bf16 v[80:83], a[52:55], v[144:147], v[80:83]
    v_mfma_f32_16x16x32_bf16 v[80:83], a[56:59], v[148:151], v[80:83]
    v_mfma_f32_16x16x32_bf16 v[80:83], a[60:63], v[152:155], v[80:83]
    s_waitcnt vmcnt(8)
    ds_read_b128 v[92:95], v2 offset:12288
    v_mfma_f32_16x16x32_bf16 v[80:83], a[64:67], v[156:159], v[80:83]
    ds_read_b128 v[96:99], v2 offset:12352
    v_mfma_f32_16x16x32_bf16 v[80:83], a[68:71], v[160:163], v[80:83]
    ds_read_b128 v[100:103], v2 offset:12416
    v_mfma_f32_16x16x32_bf16 v[80:83], a[72:75], v[164:167], v[80:83]
    ds_read_b128 v[104:107], v2 offset:12480
    v_mfma_f32_16x16x32_bf16 v[80:83], a[76:79], v[168:171], v[80:83]
    ds_read_b128 v[108:111], v3
    v_mfma_f32_16x16x32_bf16 v[84:87], a[20:23], v[132:135], v[84:87]
    v_add_u32 v3, v4, v3
    v_mfma_f32_16x16x32_bf16 v[84:87], a[24:27], v[136:139], v[84:87]
    buffer_store_dwordx4 v[60:63], v23, s[16:19], s30 offen nt
    v_mfma_f32_16x16x32_bf16 v[84:87], a[28:31], v[140:143], v[84:87]
    v_mfma_f32_16x16x32_bf16 v[84:87], a[32:35], v[144:147], v[84:87]
    v_mfma_f32_16x16x32_bf16 v[84:87], a[36:39], v[148:151], v[84:87]
    v_mfma_f32_16x16x32_bf16 v[84:87], a[40:43], v[152:155], v[84:87]
    s_waitcnt vmcnt(8)
    ds_read_b128 v[112:115], v2 offset:13312
    s_add_u32 m0, s28, 8192
    v_mfma_f32_16x16x32_bf16 v[84:87], a[44:47], v[156:159], v[84:87]
    ds_read_b128 v[116:119], v2 offset:13376
    v_add_u32 v25, s7, v25
    v_mfma_f32_16x16x32_bf16 v[84:87], a[48:51], v[160:163], v[84:87]
    ds_read_b128 v[120:123], v2 offset:13440
    v_mfma_f32_16x16x32_bf16 v[84:87], a[52:55], v[164:167], v[84:87]
    ds_read_b128 v[124:127], v2 offset:13504
    v_mfma_f32_16x16x32_bf16 v[84:87], a[56:59], v[168:171], v[84:87]
    ds_read_b128 v[128:131], v3
    v_mfma_f32_16x16x32_bf16 v[88:91], a[180:183], v[132:135], v[88:91]
    v_add_u32 v3, v4, v3
    v_mfma_f32_16x16x32_bf16 v[88:91], a[184:187], v[136:139], v[88:91]
    buffer_load_dwordx4 v25, s[8:11], 0 offen lds
    v_mfma_f32_16x16x32_bf16 v[88:91], a[188:191], v[140:143], v[88:91]
    v_mfma_f32_16x16x32_bf16 v[88:91], a[192:195], v[144:147], v[88:91]
    v_mfma_f32_16x16x32_bf16 v[88:91], a[196:199], v[148:151], v[88:91]
    v_mfma_f32_16x16x32_bf16 v[88:91], a[200:203], v[152:155], v[88:91]
    v_mfma_f32_16x16x32_bf16 v[88:91], a[204:207], v[156:159], v[88:91]
    v_mfma_f32_16x16x32_bf16 v[88:91], a[208:211], v[160:163], v[88:91]
    v_mfma_f32_16x16x32_bf16 v[88:91], a[212:215], v[164:167], v[88:91]
    v_mfma_f32_16x16x32_bf16 v[88:91], a[216:219], v[168:171], v[88:91]
    s_waitcnt lgkmcnt(0)
    v_mfma_f32_16x16x32_bf16 v[68:71], a[120:123], v[92:95], v[68:71]
    ds_read_b128 v[176:179], v5
    v_mfma_f32_16x16x32_bf16 v[68:71], a[124:127], v[96:99], v[68:71]
    v_add_u32 v5, v6, v5
    v_mfma_f32_16x16x32_bf16 v[68:71], a[128:131], v[100:103], v[68:71]
    v_mfma_f32_16x16x32_bf16 v[68:71], a[132:135], v[104:107], v[68:71]
    v_mfma_f32_16x16x32_bf16 v[68:71], a[136:139], v[108:111], v[68:71]
    v_mfma_f32_16x16x32_bf16 v[72:75], a[100:103], v[92:95], v[72:75]
    v_mfma_f32_16x16x32_bf16 v[72:75], a[104:107], v[96:99], v[72:75]
    v_mfma_f32_16x16x32_bf16 v[72:75], a[108:111], v[100:103], v[72:75]
    v_mfma_f32_16x16x32_bf16 v[72:75], a[112:115], v[104:107], v[72:75]
    v_mfma_f32_16x16x32_bf16 v[72:75], a[116:119], v[108:111], v[72:75]
    v_mfma_f32_16x16x32_bf16 v[72:75], a[120:123], v[112:115], v[72:75]
    v_mfma_f32_16x16x32_bf16 v[72:75], a[124:127], v[116:119], v[72:75]
    v_mfma_f32_16x16x32_bf16 v[72:75], a[128:131], v[120:123], v[72:75]
    v_mfma_f32_16x16x32_bf16 v[72:75], a[132:135], v[124:127], v[72:75]
    v_mfma_f32_16x16x32_bf16 v[72:75], a[136:139], v[128:131], v[72:75]
    v_mfma_f32_16x16x32_bf16 v[76:79], v[184:187], v[92:95], v[76:79]
    s_add_u32 m0, s28, 9216
    v_add_u32 v25, s7, v25
    v_mfma_f32_16x16x32_bf16 v[76:79], v[188:191], v[96:99], v[76:79]
    buffer_load_dwordx4 v25, s[8:11], 0 offen lds
    v_mfma_f32_16x16x32_bf16 v[76:79], v[192:195], v[100:103], v[76:79]
    v_mfma_f32_16x16x32_bf16 v[76:79], v[196:199], v[104:107], v[76:79]
    v_mfma_f32_16x16x32_bf16 v[76:79], v[200:203], v[108:111], v[76:79]
    v_mfma_f32_16x16x32_bf16 v[76:79], v[204:207], v[112:115], v[76:79]
    v_mfma_f32_16x16x32_bf16 v[76:79], v[208:211], v[116:119], v[76:79]
    v_mfma_f32_16x16x32_bf16 v[76:79], v[212:215], v[120:123], v[76:79]
    v_mfma_f32_16x16x32_bf16 v[76:79], v[216:219], v[124:127], v[76:79]
    v_mfma_f32_16x16x32_bf16 v[76:79], v[220:223], v[128:131], v[76:79]
    s_waitcnt lgkmcnt(0)
    v_mfma_f32_16x16x32_bf16 v[68:71], v[228:231], v[176:179], v[68:71]
    v_mfma_f32_16x16x32_bf16 v[72:75], v[236:239], v[176:179], v[72:75]
    v_mfma_f32_16x16x32_bf16 v[76:79], v[244:247], v[176:179], v[76:79]
    v_mfma_f32_16x16x32_bf16 v[32:35], v[224:227], v[176:179], 0
    v_mfma_f32_16x16x32_bf16 v[36:39], v[232:235], v[176:179], 0
    v_mfma_f32_16x16x32_bf16 v[40:43], v[240:243], v[176:179], 0
    v_mfma_f32_16x16x32_bf16 v[32:35], a[0:3], v[132:135], v[32:35]
    v_mfma_f32_16x16x32_bf16 v[32:35], a[4:7], v[136:139], v[32:35]
    v_mfma_f32_16x16x32_bf16 v[32:35], a[8:11], v[140:143], v[32:35]
    v_mfma_f32_16x16x32_bf16 v[32:35], a[12:15], v[144:147], v[32:35]
    v_mfma_f32_16x16x32_bf16 v[32:35], a[16:19], v[148:151], v[32:35]
    v_cvt_pk_bf16_f32 v68, v68, v69
    v_cvt_pk_bf16_f32 v69, v70, v71
    v_mfma_f32_16x16x32_bf16 v[32:35], a[20:23], v[152:155], v[32:35]
    v_cvt_pk_bf16_f32 v72, v72, v73
    v_cvt_pk_bf16_f32 v73, v74, v75
    v_mfma_f32_16x16x32_bf16 v[32:35], a[24:27], v[156:159], v[32:35]
    v_cvt_pk_bf16_f32 v76, v76, v77
    v_cvt_pk_bf16_f32 v77, v78, v79
    v_mfma_f32_16x16x32_bf16 v[32:35], a[28:31], v[160:163], v[32:35]
    ds_write_b64 v20, v[68:69] offset:0
    v_mfma_f32_16x16x32_bf16 v[32:35], a[32:35], v[164:167], v[32:35]
    v_mfma_f32_16x16x32_bf16 v[32:35], a[36:39], v[168:171], v[32:35]
    ds_write_b64 v20, v[72:73] offset:768
    v_mfma_f32_16x16x32_bf16 v[36:39], a[0:3], v[152:155], v[36:39]
    v_mfma_f32_16x16x32_bf16 v[36:39], a[4:7], v[156:159], v[36:39]
    ds_write_b64 v21, v[76:77] offset:0
    v_mfma_f32_16x16x32_bf16 v[36:39], a[8:11], v[160:163], v[36:39]
    s_add_u32 m0, s28, 16384
    v_add_u32 v18, s7, v18
    ds_read_b128 v[68:71], v22 offset:0
    v_mfma_f32_16x16x32_bf16 v[36:39], a[12:15], v[164:167], v[36:39]
    buffer_load_dwordx4 v18, s[8:11], 0 offen lds
    v_mfma_f32_16x16x32_bf16 v[36:39], a[16:19], v[168:171], v[36:39]
    ds_read_b128 v[72:75], v22 offset:768
    s_add_u32 s30, s30, s7
    v_mfma_f32_16x16x32_bf16 v[40:43], a[140:143], v[132:135], v[40:43]
    v_mfma_f32_16x16x32_bf16 v[40:43], a[144:147], v[136:139], v[40:43]
    v_mfma_f32_16x16x32_bf16 v[40:43], a[148:151], v[140:143], v[40:43]
    v_mfma_f32_16x16x32_bf16 v[40:43], a[152:155], v[144:147], v[40:43]
    v_mfma_f32_16x16x32_bf16 v[40:43], a[156:159], v[148:151], v[40:43]
    v_mfma_f32_16x16x32_bf16 v[40:43], a[160:163], v[152:155], v[40:43]
    v_mfma_f32_16x16x32_bf16 v[40:43], a[164:167], v[156:159], v[40:43]
    v_mfma_f32_16x16x32_bf16 v[40:43], a[168:171], v[160:163], v[40:43]
    v_mfma_f32_16x16x32_bf16 v[40:43], a[172:175], v[164:167], v[40:43]
    s_waitcnt lgkmcnt(0)
    buffer_store_dwordx4 v[68:71], v23, s[16:19], s30 offen nt
    v_mfma_f32_16x16x32_bf16 v[40:43], a[176:179], v[168:171], v[40:43]
    s_add_u32 s30, s30, s7
    v_mfma_f32_16x16x32_bf16 v[80:83], a[80:83], v[92:95], v[80:83]
    v_mfma_f32_16x16x32_bf16 v[80:83], a[84:87], v[96:99], v[80:83]
    s_add_u32 m0, s28, 17408
    v_add_u32 v18, s7, v18
    v_mfma_f32_16x16x32_bf16 v[80:83], a[88:91], v[100:103], v[80:83]
    buffer_load_dwordx4 v18, s[8:11], 0 offen lds
    v_mfma_f32_16x16x32_bf16 v[80:83], a[92:95], v[104:107], v[80:83]
    v_mfma_f32_16x16x32_bf16 v[80:83], a[96:99], v[108:111], v[80:83]
    v_mfma_f32_16x16x32_bf16 v[80:83], a[100:103], v[112:115], v[80:83]
    s_waitcnt vmcnt(9)
    ds_read_b128 v[132:135], v2 offset:14336
    v_mfma_f32_16x16x32_bf16 v[80:83], a[104:107], v[116:119], v[80:83]
    ds_read_b128 v[136:139], v2 offset:14400
    v_mfma_f32_16x16x32_bf16 v[80:83], a[108:111], v[120:123], v[80:83]
    ds_read_b128 v[140:143], v2 offset:14464
    v_mfma_f32_16x16x32_bf16 v[80:83], a[112:115], v[124:127], v[80:83]
    ds_read_b128 v[144:147], v2 offset:14528
    v_mfma_f32_16x16x32_bf16 v[80:83], a[116:119], v[128:131], v[80:83]
    ds_read_b128 v[148:151], v3
    v_mfma_f32_16x16x32_bf16 v[84:87], a[60:63], v[92:95], v[84:87]
    v_add_u32 v3, v4, v3
    v_mfma_f32_16x16x32_bf16 v[84:87], a[64:67], v[96:99], v[84:87]
    buffer_store_dwordx4 v[72:75], v23, s[16:19], s30 offen nt
    v_mfma_f32_16x16x32_bf16 v[84:87], a[68:71], v[100:103], v[84:87]
    v_mfma_f32_16x16x32_bf16 v[84:87], a[72:75], v[104:107], v[84:87]
    v_mfma_f32_16x16x32_bf16 v[84:87], a[76:79], v[108:111], v[84:87]
    v_mfma_f32_16x16x32_bf16 v[84:87], a[80:83], v[112:115], v[84:87]
    s_waitcnt vmcnt(7)
    ds_read_b128 v[152:155], v2 offset:15360
    v_mfma_f32_16x16x32_bf16 v[84:87], a[84:87], v[116:119], v[84:87]
    ds_read_b128 v[156:159], v2 offset:15424
    v_mfma_f32_16x16x32_bf16 v[84:87], a[88:91], v[120:123], v[84:87]
    ds_read_b128 v[160:163], v2 offset:15488
    v_mfma_f32_16x16x32_bf16 v[84:87], a[92:95], v[124:127], v[84:87]
    ds_read_b128 v[164:167], v2 offset:15552
    v_mfma_f32_16x16x32_bf16 v[84:87], a[96:99], v[128:131], v[84:87]
    ds_read_b128 v[168:171], v3
    v_mfma_f32_16x16x32_bf16 v[88:91], a[220:223], v[92:95], v[88:91]
    v_add_u32 v3, v4, v3
    v_mfma_f32_16x16x32_bf16 v[88:91], a[224:227], v[96:99], v[88:91]
    v_mfma_f32_16x16x32_bf16 v[88:91], a[228:231], v[100:103], v[88:91]
    v_mfma_f32_16x16x32_bf16 v[88:91], a[232:235], v[104:107], v[88:91]
    v_mfma_f32_16x16x32_bf16 v[88:91], a[236:239], v[108:111], v[88:91]
    v_mfma_f32_16x16x32_bf16 v[88:91], a[240:243], v[112:115], v[88:91]
    v_mfma_f32_16x16x32_bf16 v[88:91], a[244:247], v[116:119], v[88:91]
    v_mfma_f32_16x16x32_bf16 v[88:91], a[248:251], v[120:123], v[88:91]
    v_mfma_f32_16x16x32_bf16 v[88:91], a[252:255], v[124:127], v[88:91]
    v_mfma_f32_16x16x32_bf16 v[88:91], v[180:183], v[128:131], v[88:91]
    s_waitcnt lgkmcnt(0)
    v_mfma_f32_16x16x32_bf16 v[80:83], a[120:123], v[132:135], v[80:83]
    ds_read_b128 v[172:175], v5
    v_mfma_f32_16x16x32_bf16 v[80:83], a[124:127], v[136:139], v[80:83]
    v_add_u32 v5, v6, v5
    v_mfma_f32_16x16x32_bf16 v[80:83], a[128:131], v[140:143], v[80:83]
    v_mfma_f32_16x16x32_bf16 v[80:83], a[132:135], v[144:147], v[80:83]
    v_mfma_f32_16x16x32_bf16 v[80:83], a[136:139], v[148:151], v[80:83]
    v_mfma_f32_16x16x32_bf16 v[84:87], a[100:103], v[132:135], v[84:87]
    v_mfma_f32_16x16x32_bf16 v[84:87], a[104:107], v[136:139], v[84:87]
    v_mfma_f32_16x16x32_bf16 v[84:87], a[108:111], v[140:143], v[84:87]
    v_mfma_f32_16x16x32_bf16 v[84:87], a[112:115], v[144:147], v[84:87]
    v_mfma_f32_16x16x32_bf16 v[84:87], a[116:119], v[148:151], v[84:87]
    v_mfma_f32_16x16x32_bf16 v[84:87], a[120:123], v[152:155], v[84:87]
    v_mfma_f32_16x16x32_bf16 v[84:87], a[124:127], v[156:159], v[84:87]
    v_mfma_f32_16x16x32_bf16 v[84:87], a[128:131], v[160:163], v[84:87]
    v_mfma_f32_16x16x32_bf16 v[84:87], a[132:135], v[164:167], v[84:87]
    v_mfma_f32_16x16x32_bf16 v[84:87], a[136:139], v[168:171], v[84:87]
    v_mfma_f32_16x16x32_bf16 v[88:91], v[184:187], v[132:135], v[88:91]
    v_mfma_f32_16x16x32_bf16 v[88:91], v[188:191], v[136:139], v[88:91]
    v_mfma_f32_16x16x32_bf16 v[88:91], v[192:195], v[140:143], v[88:91]
    v_mfma_f32_16x16x32_bf16 v[88:91], v[196:199], v[144:147], v[88:91]
    v_mfma_f32_16x16x32_bf16 v[88:91], v[200:203], v[148:151], v[88:91]
    v_mfma_f32_16x16x32_bf16 v[88:91], v[204:207], v[152:155], v[88:91]
    v_mfma_f32_16x16x32_bf16 v[88:91], v[208:211], v[156:159], v[88:91]
    v_mfma_f32_16x16x32_bf16 v[88:91], v[212:215], v[160:163], v[88:91]
    v_mfma_f32_16x16x32_bf16 v[88:91], v[216:219], v[164:167], v[88:91]
    v_mfma_f32_16x16x32_bf16 v[88:91], v[220:223], v[168:171], v[88:91]
    s_waitcnt lgkmcnt(0)
    v_mfma_f32_16x16x32_bf16 v[80:83], v[228:231], v[172:175], v[80:83]
    v_mfma_f32_16x16x32_bf16 v[84:87], v[236:239], v[172:175], v[84:87]
    v_mfma_f32_16x16x32_bf16 v[88:91], v[244:247], v[172:175], v[88:91]
    v_mfma_f32_16x16x32_bf16 v[32:35], a[40:43], v[92:95], v[32:35]
    v_mfma_f32_16x16x32_bf16 v[32:35], a[44:47], v[96:99], v[32:35]
    v_mfma_f32_16x16x32_bf16 v[32:35], a[48:51], v[100:103], v[32:35]
    v_mfma_f32_16x16x32_bf16 v[32:35], a[52:55], v[104:107], v[32:35]
    v_mfma_f32_16x16x32_bf16 v[32:35], a[56:59], v[108:111], v[32:35]
    v_mfma_f32_16x16x32_bf16 v[32:35], a[60:63], v[112:115], v[32:35]
    v_mfma_f32_16x16x32_bf16 v[32:35], a[64:67], v[116:119], v[32:35]
    v_mfma_f32_16x16x32_bf16 v[32:35], a[68:71], v[120:123], v[32:35]
    v_cvt_pk_bf16_f32 v80, v80, v81
    v_cvt_pk_bf16_f32 v81, v82, v83
    v_mfma_f32_16x16x32_bf16 v[32:35], a[72:75], v[124:127], v[32:35]
    v_cvt_pk_bf16_f32 v84, v84, v85
    v_cvt_pk_bf16_f32 v85, v86, v87
    v_mfma_f32_16x16x32_bf16 v[32:35], a[76:79], v[128:131], v[32:35]
    v_cvt_pk_bf16_f32 v88, v88, v89
    v_cvt_pk_bf16_f32 v89, v90, v91
    v_mfma_f32_16x16x32_bf16 v[36:39], a[20:23], v[92:95], v[36:39]
    ds_write_b64 v20, v[80:81] offset:0
    v_mfma_f32_16x16x32_bf16 v[36:39], a[24:27], v[96:99], v[36:39]
    v_mfma_f32_16x16x32_bf16 v[36:39], a[28:31], v[100:103], v[36:39]
    ds_write_b64 v20, v[84:85] offset:768
    v_mfma_f32_16x16x32_bf16 v[36:39], a[32:35], v[104:107], v[36:39]
    v_mfma_f32_16x16x32_bf16 v[36:39], a[36:39], v[108:111], v[36:39]
    ds_write_b64 v21, v[88:89] offset:0
    v_mfma_f32_16x16x32_bf16 v[36:39], a[40:43], v[112:115], v[36:39]
    ds_read_b128 v[80:83], v22 offset:0
    v_mfma_f32_16x16x32_bf16 v[36:39], a[44:47], v[116:119], v[36:39]
    ds_read_b128 v[84:87], v22 offset:768
    s_add_u32 s30, s30, s7
    v_mfma_f32_16x16x32_bf16 v[36:39], a[48:51], v[120:123], v[36:39]
    v_mfma_f32_16x16x32_bf16 v[36:39], a[52:55], v[124:127], v[36:39]
    v_mfma_f32_16x16x32_bf16 v[36:39], a[56:59], v[128:131], v[36:39]
    v_mfma_f32_16x16x32_bf16 v[40:43], a[180:183], v[92:95], v[40:43]
    v_mfma_f32_16x16x32_bf16 v[40:43], a[184:187], v[96:99], v[40:43]
    v_mfma_f32_16x16x32_bf16 v[40:43], a[188:191], v[100:103], v[40:43]
    v_mfma_f32_16x16x32_bf16 v[40:43], a[192:195], v[104:107], v[40:43]
    v_mfma_f32_16x16x32_bf16 v[40:43], a[196:199], v[108:111], v[40:43]
    v_mfma_f32_16x16x32_bf16 v[40:43], a[200:203], v[112:115], v[40:43]
    s_waitcnt lgkmcnt(0)
    buffer_store_dwordx4 v[80:83], v23, s[16:19], s30 offen
    v_mfma_f32_16x16x32_bf16 v[40:43], a[204:207], v[116:119], v[40:43]
    s_add_u32 s30, s30, s7
    v_mfma_f32_16x16x32_bf16 v[40:43], a[208:211], v[120:123], v[40:43]
    v_mfma_f32_16x16x32_bf16 v[40:43], a[212:215], v[124:127], v[40:43]
    v_mfma_f32_16x16x32_bf16 v[40:43], a[216:219], v[128:131], v[40:43]
    v_mfma_f32_16x16x32_bf16 v[32:35], a[80:83], v[132:135], v[32:35]
    v_mfma_f32_16x16x32_bf16 v[32:35], a[84:87], v[136:139], v[32:35]
    v_mfma_f32_16x16x32_bf16 v[32:35], a[88:91], v[140:143], v[32:35]
    v_mfma_f32_16x16x32_bf16 v[32:35], a[92:95], v[144:147], v[32:35]
    v_mfma_f32_16x16x32_bf16 v[32:35], a[96:99], v[148:151], v[32:35]
    v_mfma_f32_16x16x32_bf16 v[32:35], a[100:103], v[152:155], v[32:35]
    s_waitcnt vmcnt(4)
    ds_read_b128 v[92:95], v2 offset:16384
    v_mfma_f32_16x16x32_bf16 v[32:35], a[104:107], v[156:159], v[32:35]
    ds_read_b128 v[96:99], v2 offset:16448
    v_mfma_f32_16x16x32_bf16 v[32:35], a[108:111], v[160:163], v[32:35]
    ds_read_b128 v[100:103], v2 offset:16512
    v_mfma_f32_16x16x32_bf16 v[32:35], a[112:115], v[164:167], v[32:35]
    ds_read_b128 v[104:107], v2 offset:16576
    v_mfma_f32_16x16x32_bf16 v[32:35], a[116:119], v[168:171], v[32:35]
    ds_read_b128 v[108:111], v3
    v_mfma_f32_16x16x32_bf16 v[36:39], a[60:63], v[132:135], v[36:39]
    v_add_u32 v3, v4, v3
    v_mfma_f32_16x16x32_bf16 v[36:39], a[64:67], v[136:139], v[36:39]
    buffer_store_dwordx4 v[84:87], v23, s[16:19], s30 offen
    v_mfma_f32_16x16x32_bf16 v[36:39], a[68:71], v[140:143], v[36:39]
    v_mfma_f32_16x16x32_bf16 v[36:39], a[72:75], v[144:147], v[36:39]
    v_mfma_f32_16x16x32_bf16 v[36:39], a[76:79], v[148:151], v[36:39]
    v_mfma_f32_16x16x32_bf16 v[36:39], a[80:83], v[152:155], v[36:39]
    s_waitcnt vmcnt(3)
    ds_read_b128 v[112:115], v2 offset:17408
    v_mfma_f32_16x16x32_bf16 v[36:39], a[84:87], v[156:159], v[36:39]
    ds_read_b128 v[116:119], v2 offset:17472
    v_mfma_f32_16x16x32_bf16 v[36:39], a[88:91], v[160:163], v[36:39]
    ds_read_b128 v[120:123], v2 offset:17536
    v_mfma_f32_16x16x32_bf16 v[36:39], a[92:95], v[164:167], v[36:39]
    ds_read_b128 v[124:127], v2 offset:17600
    v_mfma_f32_16x16x32_bf16 v[36:39], a[96:99], v[168:171], v[36:39]
    ds_read_b128 v[128:131], v3
    v_mfma_f32_16x16x32_bf16 v[40:43], a[220:223], v[132:135], v[40:43]
    v_mad_i32_i24 v3, v4, -15, v3
    v_mfma_f32_16x16x32_bf16 v[40:43], a[224:227], v[136:139], v[40:43]
    v_mfma_f32_16x16x32_bf16 v[40:43], a[228:231], v[140:143], v[40:43]
    v_mfma_f32_16x16x32_bf16 v[40:43], a[232:235], v[144:147], v[40:43]
    v_mfma_f32_16x16x32_bf16 v[40:43], a[236:239], v[148:151], v[40:43]
    v_mfma_f32_16x16x32_bf16 v[40:43], a[240:243], v[152:155], v[40:43]
    v_mfma_f32_16x16x32_bf16 v[40:43], a[244:247], v[156:159], v[40:43]
    v_mfma_f32_16x16x32_bf16 v[40:43], a[248:251], v[160:163], v[40:43]
    v_mfma_f32_16x16x32_bf16 v[40:43], a[252:255], v[164:167], v[40:43]
    v_mfma_f32_16x16x32_bf16 v[40:43], v[180:183], v[168:171], v[40:43]
    s_waitcnt lgkmcnt(0)
    v_mfma_f32_16x16x32_bf16 v[32:35], a[120:123], v[92:95], v[32:35]
    ds_read_b128 v[176:179], v5
    v_mfma_f32_16x16x32_bf16 v[32:35], a[124:127], v[96:99], v[32:35]
    v_mad_i32_i24 v5, v6, -6, v5
    v_mfma_f32_16x16x32_bf16 v[32:35], a[128:131], v[100:103], v[32:35]
    v_mfma_f32_16x16x32_bf16 v[32:35], a[132:135], v[104:107], v[32:35]
    ds_read_b128 v[132:135], v2 offset:2048
    v_mfma_f32_16x16x32_bf16 v[32:35], a[136:139], v[108:111], v[32:35]
    ds_read_b128 v[136:139], v2 offset:2112
    v_mfma_f32_16x16x32_bf16 v[36:39], a[100:103], v[92:95], v[36:39]
    ds_read_b128 v[140:143], v2 offset:2176
    v_mfma_f32_16x16x32_bf16 v[36:39], a[104:107], v[96:99], v[36:39]
    ds_read_b128 v[144:147], v2 offset:2240
    v_mfma_f32_16x16x32_bf16 v[36:39], a[108:111], v[100:103], v[36:39]
    ds_read_b128 v[148:151], v3
    v_mfma_f32_16x16x32_bf16 v[36:39], a[112:115], v[104:107], v[36:39]
    ds_read_b128 v[152:155], v2 offset:3072
    v_add_u32 v3, v4, v3
    v_mfma_f32_16x16x32_bf16 v[36:39], a[116:119], v[108:111], v[36:39]
    ds_read_b128 v[156:159], v2 offset:3136
    v_mfma_f32_16x16x32_bf16 v[36:39], a[120:123], v[112:115], v[36:39]
    ds_read_b128 v[160:163], v2 offset:3200
    v_mfma_f32_16x16x32_bf16 v[36:39], a[124:127], v[116:119], v[36:39]
    ds_read_b128 v[164:167], v2 offset:3264
    v_mfma_f32_16x16x32_bf16 v[36:39], a[128:131], v[120:123], v[36:39]
    ds_read_b128 v[168:171], v3
    v_mfma_f32_16x16x32_bf16 v[36:39], a[132:135], v[124:127], v[36:39]
    v_add_u32 v3, v4, v3
    v_mfma_f32_16x16x32_bf16 v[36:39], a[136:139], v[128:131], v[36:39]
    v_mfma_f32_16x16x32_bf16 v[40:43], v[184:187], v[92:95], v[40:43]
    ds_read_b128 v[92:95], v2 offset:4096
    v_mfma_f32_16x16x32_bf16 v[40:43], v[188:191], v[96:99], v[40:43]
    ds_read_b128 v[96:99], v2 offset:4160
    v_mfma_f32_16x16x32_bf16 v[40:43], v[192:195], v[100:103], v[40:43]
    ds_read_b128 v[100:103], v2 offset:4224
    v_mfma_f32_16x16x32_bf16 v[40:43], v[196:199], v[104:107], v[40:43]
    ds_read_b128 v[104:107], v2 offset:4288
    v_mfma_f32_16x16x32_bf16 v[40:43], v[200:203], v[108:111], v[40:43]
    ds_read_b128 v[108:111], v3
    v_mfma_f32_16x16x32_bf16 v[40:43], v[204:207], v[112:115], v[40:43]
    ds_read_b128 v[112:115], v2 offset:5120
    v_add_u32 v3, v4, v3
    v_mfma_f32_16x16x32_bf16 v[40:43], v[208:211], v[116:119], v[40:43]
    ds_read_b128 v[116:119], v2 offset:5184
    v_mfma_f32_16x16x32_bf16 v[40:43], v[212:215], v[120:123], v[40:43]
    ds_read_b128 v[120:123], v2 offset:5248
    v_mfma_f32_16x16x32_bf16 v[40:43], v[216:219], v[124:127], v[40:43]
    ds_read_b128 v[124:127], v2 offset:5312
    v_mfma_f32_16x16x32_bf16 v[40:43], v[220:223], v[128:131], v[40:43]
    s_waitcnt lgkmcnt(8)
    ds_read_b128 v[128:131], v3
    v_mfma_f32_16x16x32_bf16 v[32:35], v[228:231], v[176:179], v[32:35]
    ds_read_b128 v[172:175], v5
    v_add_u32 v3, v4, v3
    v_mfma_f32_16x16x32_bf16 v[36:39], v[236:239], v[176:179], v[36:39]
    v_mad_i32_i24 v5, v6, 2, v5
    v_mfma_f32_16x16x32_bf16 v[40:43], v[244:247], v[176:179], v[40:43]
    s_cmp_eq_u32 s35, 3
    s_cbranch_scc1 L_none
    s_cmp_lg_u32 s35, 2
    s_cbranch_scc1 L_varA
    v_mfma_f32_16x16x32_bf16 v[44:47], a[140:143], v[132:135], 0
    ds_read_b128 v[132:135], v2 offset:6144
    v_mfma_f32_16x16x32_bf16 v[44:47], a[144:147], v[136:139], v[44:47]
    ds_read_b128 v[136:139], v2 offset:6208
    v_mfma_f32_16x16x32_bf16 v[44:47], a[148:151], v[140:143], v[44:47]
    ds_read_b128 v[140:143], v2 offset:6272
    v_mfma_f32_16x16x32_bf16 v[44:47], a[152:155], v[144:147], v[44:47]
    ds_read_b128 v[144:147], v2 offset:6336
    v_mfma_f32_16x16x32_bf16 v[44:47], a[156:159], v[148:151], v[44:47]
    ds_read_b128 v[148:151], v3
    v_mfma_f32_16x16x32_bf16 v[44:47], a[160:163], v[152:155], v[44:47]
    ds_read_b128 v[152:155], v2 offset:7168
    v_add_u32 v3, v4, v3
    v_mfma_f32_16x16x32_bf16 v[44:47], a[164:167], v[156:159], v[44:47]
    ds_read_b128 v[156:159], v2 offset:7232
    v_mfma_f32_16x16x32_bf16 v[44:47], a[168:171], v[160:163], v[44:47]
    v_cvt_pk_bf16_f32 v32, v32, v33
    v_cvt_pk_bf16_f32 v33, v34, v35
    v_mfma_f32_16x16x32_bf16 v[44:47], a[172:175], v[164:167], v[44:47]
    v_cvt_pk_bf16_f32 v36, v36, v37
    v_cvt_pk_bf16_f32 v37, v38, v39
    v_mfma_f32_16x16x32_bf16 v[44:47], a[176:179], v[168:171], v[44:47]
    v_cvt_pk_bf16_f32 v40, v40, v41
    v_cvt_pk_bf16_f32 v41, v42, v43
    v_mfma_f32_16x16x32_bf16 v[44:47], a[180:183], v[92:95], v[44:47]
    s_waitcnt lgkmcnt(5)
    ds_write_b64 v20, v[32:33] offset:0
    v_mfma_f32_16x16x32_bf16 v[44:47], a[184:187], v[96:99], v[44:47]
    ds_write_b64 v20, v[36:37] offset:768
    v_mfma_f32_16x16x32_bf16 v[44:47], a[188:191], v[100:103], v[44:47]
    ds_write_b64 v21, v[40:41] offset:0
    v_mfma_f32_16x16x32_bf16 v[44:47], a[192:195], v[104:107], v[44:47]
    ds_read_b128 v[32:35], v22 offset:0
    v_mfma_f32_16x16x32_bf16 v[44:47], a[196:199], v[108:111], v[44:47]
    ds_read_b128 v[36:39], v22 offset:768
    s_add_u32 s30, s30, s7
    v_mfma_f32_16x16x32_bf16 v[44:47], a[200:203], v[112:115], v[44:47]
    ds_read_b128 v[160:163], v2 offset:7296
    v_mfma_f32_16x16x32_bf16 v[44:47], a[204:207], v[116:119], v[44:47]
    ds_read_b128 v[164:167], v2 offset:7360
    v_mfma_f32_16x16x32_bf16 v[44:47], a[208:211], v[120:123], v[44:47]
    ds_read_b128 v[168:171], v3
    v_mfma_f32_16x16x32_bf16 v[44:47], a[212:215], v[124:127], v[44:47]
    ds_read_b128 v[92:95], v2 offset:8192
    v_add_u32 v3, v4, v3
    v_mfma_f32_16x16x32_bf16 v[44:47], a[216:219], v[128:131], v[44:47]
    ds_read_b128 v[96:99], v2 offset:8256
    v_mfma_f32_16x16x32_bf16 v[44:47], v[240:243], v[172:175], v[44:47]
    ds_read_b128 v[100:103], v2 offset:8320
    v_mfma_f32_16x16x32_bf16 v[44:47], a[220:223], v[132:135], v[44:47]
    s_waitcnt lgkmcnt(7)
    buffer_store_dwordx4 v[32:35], v23, s[16:19], s30 offen
    v_mfma_f32_16x16x32_bf16 v[44:47], a[224:227], v[136:139], v[44:47]
    s_waitcnt lgkmcnt(6)
    s_add_u32 s30, s30, s7
    buffer_store_dwordx4 v[36:39], v23, s[16:19], s30 offen
    v_mfma_f32_16x16x32_bf16 v[44:47], a[228:231], v[140:143], v[44:47]
    ds_read_b128 v[104:107], v2 offset:8384
    v_mfma_f32_16x16x32_bf16 v[44:47], a[232:235], v[144:147], v[44:47]
    ds_read_b128 v[108:111], v3
    v_mfma_f32_16x16x32_bf16 v[44:47], a[236:239], v[148:151], v[44:47]
    ds_read_b128 v[112:115], v2 offset:9216
    v_add_u32 v3, v4, v3
    v_mfma_f32_16x16x32_bf16 v[44:47], a[240:243], v[152:155], v[44:47]
    ds_read_b128 v[116:119], v2 offset:9280
    v_mfma_f32_16x16x32_bf16 v[44:47], a[244:247], v[156:159], v[44:47]
    s_waitcnt lgkmcnt(6)
    ds_read_b128 v[120:123], v2 offset:9344
    v_mfma_f32_16x16x32_bf16 v[44:47], a[248:251], v[160:163], v[44:47]
    ds_read_b128 v[124:127], v2 offset:9408
    v_mfma_f32_16x16x32_bf16 v[44:47], a[252:255], v[164:167], v[44:47]
    ds_read_b128 v[128:131], v3
    v_mfma_f32_16x16x32_bf16 v[44:47], v[180:183], v[168:171], v[44:47]
    ds_read_b128 v[176:179], v5
    v_mfma_f32_16x16x32_bf16 v[44:47], v[184:187], v[92:95], v[44:47]
    s_waitcnt lgkmcnt(8)
    v_mfma_f32_16x16x32_bf16 v[44:47], v[188:191], v[96:99], v[44:47]
    v_mfma_f32_16x16x32_bf16 v[44:47], v[192:195], v[100:103], v[44:47]
    s_waitcnt lgkmcnt(6)
    v_mfma_f32_16x16x32_bf16 v[44:47], v[196:199], v[104:107], v[44:47]
    v_mfma_f32_16x16x32_bf16 v[44:47], v[200:203], v[108:111], v[44:47]
    s_waitcnt lgkmcnt(4)
    v_mfma_f32_16x16x32_bf16 v[44:47], v[204:207], v[112:115], v[44:47]
    v_mfma_f32_16x16x32_bf16 v[44:47], v[208:211], v[116:119], v[44:47]
    s_waitcnt lgkmcnt(2)
    v_mfma_f32_16x16x32_bf16 v[44:47], v[212:215], v[120:123], v[44:47]
    v_mfma_f32_16x16x32_bf16 v[44:47], v[216:219], v[124:127], v[44:47]
    s_waitcnt lgkmcnt(0)
    v_mfma_f32_16x16x32_bf16 v[44:47], v[220:223], v[128:131], v[44:47]
    v_mfma_f32_16x16x32_bf16 v[44:47], v[244:247], v[176:179], v[44:47]
    s_nop 7
    v_cvt_pk_bf16_f32 v44, v44, v45
    v_cvt_pk_bf16_f32 v45, v46, v47
    buffer_store_dwordx2 v[44:45], v27, s[16:19], 0 offen
    s_endpgm
.p2align 12, 0
L_varA:
    s_cbranch_execz L_hopA_1
    v_mfma_f32_16x16x32_bf16 v[44:47], a[0:3], v[132:135], 0
    ds_read_b128 v[132:135], v2 offset:6144
    v_mfma_f32_16x16x32_bf16 v[44:47], a[4:7], v[136:139], v[44:47]
    ds_read_b128 v[136:139], v2 offset:6208
    v_mfma_f32_16x16x32_bf16 v[44:47], a[8:11], v[140:143], v[44:47]
    ds_read_b128 v[140:143], v2 offset:6272
    v_mfma_f32_16x16x32_bf16 v[44:47], a[12:15], v[144:147], v[44:47]
    ds_read_b128 v[144:147], v2 offset:6336
    v_mfma_f32_16x16x32_bf16 v[44:47], a[16:19], v[148:151], v[44:47]
    ds_read_b128 v[148:151], v3
    v_mfma_f32_16x16x32_bf16 v[44:47], a[20:23], v[152:155], v[44:47]
    ds_read_b128 v[152:155], v2 offset:7168
    v_add_u32 v3, v4, v3
    v_mfma_f32_16x16x32_bf16 v[44:47], a[24:27], v[156:159], v[44:47]
    ds_read_b128 v[156:159], v2 offset:7232
    v_mfma_f32_16x16x32_bf16 v[44:47], a[28:31], v[160:163], v[44:47]
    v_cvt_pk_bf16_f32 v32, v32, v33
    v_cvt_pk_bf16_f32 v33, v34, v35
L_hopA_1:
    s_cbranch_execz L_hopA_2
    v_mfma_f32_16x16x32_bf16 v[44:47], a[32:35], v[164:167], v[44:47]
    v_cvt_pk_bf16_f32 v36, v36, v37
    v_cvt_pk_bf16_f32 v37, v38, v39
    v_mfma_f32_16x16x32_bf16 v[44:47], a[36:39], v[168:171], v[44:47]
    v_cvt_pk_bf16_f32 v40, v40, v41
    v_cvt_pk_bf16_f32 v41, v42, v43
    v_mfma_f32_16x16x32_bf16 v[44:47], a[40:43], v[92:95], v[44:47]
    s_waitcnt lgkmcnt(5)
    ds_write_b64 v20, v[32:33] offset:0
    v_mfma_f32_16x16x32_bf16 v[44:47], a[44:47], v[96:99], v[44:47]
    ds_write_b64 v20, v[36:37] offset:768
    v_mfma_f32_16x16x32_bf16 v[44:47], a[48:51], v[100:103], v[44:47]
    ds_write_b64 v21, v[40:41] offset:0
    v_mfma_f32_16x16x32_bf16 v[44:47], a[52:55], v[104:107], v[44:47]
    ds_read_b128 v[32:35], v22 offset:0
    v_mfma_f32_16x16x32_bf16 v[44:47], a[56:59], v[108:111], v[44:47]
    ds_read_b128 v[36:39], v22 offset:768
    s_add_u32 s30, s30, s7
    v_mfma_f32_16x16x32_bf16 v[44:47], a[60:63], v[112:115], v[44:47]
    ds_read_b128 v[160:163], v2 offset:7296
L_hopA_2:
    s_cbranch_execz L_hopA_3
    v_mfma_f32_16x16x32_bf16 v[44:47], a[64:67], v[116:119], v[44:47]
    ds_read_b128 v[164:167], v2 offset:7360
    v_mfma_f32_16x16x32_bf16 v[44:47], a[68:71], v[120:123], v[44:47]
    ds_read_b128 v[168:171], v3
    v_mfma_f32_16x16x32_bf16 v[44:47], a[72:75], v[124:127], v[44:47]
    ds_read_b128 v[92:95], v2 offset:8192
    v_add_u32 v3, v4, v3
    v_mfma_f32_16x16x32_bf16 v[44:47], a[76:79], v[128:131], v[44:47]
    ds_read_b128 v[96:99], v2 offset:8256
    v_mfma_f32_16x16x32_bf16 v[44:47], v[224:227], v[172:175], v[44:47]
    ds_read_b128 v[100:103], v2 offset:8320
    v_mfma_f32_16x16x32_bf16 v[44:47], a[80:83], v[132:135], v[44:47]
    s_waitcnt lgkmcnt(7)
    buffer_store_dwordx4 v[32:35], v23, s[16:19], s30 offen
    v_mfma_f32_16x16x32_bf16 v[44:47], a[84:87], v[136:139], v[44:47]
    s_waitcnt lgkmcnt(6)
    s_add_u32 s30, s30, s7
    buffer_store_dwordx4 v[36:39], v23, s[16:19], s30 offen
    v_mfma_f32_16x16x32_bf16 v[44:47], a[88:91], v[140:143], v[44:47]
    ds_read_b128 v[104:107], v2 offset:8384
L_hopA_3:
    s_cbranch_execz L_hopA_4
    v_mfma_f32_16x16x32_bf16 v[44:47], a[92:95], v[144:147], v[44:47]
    ds_read_b128 v[108:111], v3
    v_mfma_f32_16x16x32_bf16 v[44:47], a[96:99], v[148:151], v[44:47]
    ds_read_b128 v[176:179], v5
    v_add_u32 v3, v4, v3
    v_mfma_f32_16x16x32_bf16 v[44:47], a[100:103], v[152:155], v[44:47]
    v_mfma_f32_16x16x32_bf16 v[44:47], a[104:107], v[156:159], v[44:47]
    s_waitcnt lgkmcnt(5)
    v_mfma_f32_16x16x32_bf16 v[44:47], a[108:111], v[160:163], v[44:47]
    v_mfma_f32_16x16x32_bf16 v[44:47], a[112:115], v[164:167], v[44:47]
    v_mfma_f32_16x16x32_bf16 v[44:47], a[116:119], v[168:171], v[44:47]
    v_mfma_f32_16x16x32_bf16 v[44:47], a[120:123], v[92:95], v[44:47]
    s_waitcnt lgkmcnt(3)
L_hopA_4:
    s_cbranch_execz L_none
    v_mfma_f32_16x16x32_bf16 v[44:47], a[124:127], v[96:99], v[44:47]
    v_mfma_f32_16x16x32_bf16 v[44:47], a[128:131], v[100:103], v[44:47]
    s_waitcnt lgkmcnt(1)
    v_mfma_f32_16x16x32_bf16 v[44:47], a[132:135], v[104:107], v[44:47]
    v_mfma_f32_16x16x32_bf16 v[44:47], a[136:139], v[108:111], v[44:47]
    s_waitcnt lgkmcnt(0)
    v_mfma_f32_16x16x32_bf16 v[44:47], v[228:231], v[176:179], v[44:47]
    s_nop 7
    v_cvt_pk_bf16_f32 v44, v44, v45
    v_cvt_pk_bf16_f32 v45, v46, v47
    buffer_store_dwordx2 v[44:45], v27, s[16:19], 0 offen
    s_endpgm
L_none:
    s_cbranch_execz L_hopback
    s_nop 7
    v_cvt_pk_bf16_f32 v32, v32, v33
    v_cvt_pk_bf16_f32 v33, v34, v35
    v_cvt_pk_bf16_f32 v36, v36, v37
    v_cvt_pk_bf16_f32 v37, v38, v39
    v_cvt_pk_bf16_f32 v40, v40, v41
    v_cvt_pk_bf16_f32 v41, v42, v43
    ds_write_b64 v20, v[32:33] offset:0
    ds_write_b64 v20, v[36:37] offset:768
    ds_write_b64 v21, v[40:41] offset:0
    ds_read_b128 v[32:35], v22 offset:0
    ds_read_b128 v[36:39], v22 offset:768
    s_add_u32 s30, s30, s7
    s_waitcnt lgkmcnt(0)
    buffer_store_dwordx4 v[32:35], v23, s[16:19], s30 offen
    s_add_u32 s30, s30, s7
    buffer_store_dwordx4 v[36:39], v23, s[16:19], s30 offen
L_fin:
L_end:
    s_endpgm
.section .rodata,"a"
.p2align 6
.amdhsa_kernel standalone__grouped__vision_kernel
  .amdhsa_next_free_vgpr 512
  .amdhsa_next_free_sgpr 102
  .amdhsa_accum_offset 256
  .amdhsa_group_segment_fixed_size 0
  .amdhsa_kernarg_size 40
  .amdhsa_user_sgpr_count 2
  .amdhsa_user_sgpr_kernarg_segment_ptr 1
  .amdhsa_system_sgpr_workgroup_id_x 1
.end_amdhsa_kernel
```
